```python
import torch

def _softmax(x, axis=-1):
    return torch.softmax(x, dim=axis)
def _gelu(x):
    return torch.nn.functional.gelu(x, approximate="tanh")
def _silu(x):
    return torch.nn.functional.silu(x)
def _sigmoid(x):
    return torch.sigmoid(x)
def _layernorm(x, axis=-1, eps=1e-5):
    m = x.mean(dim=axis, keepdim=True)
    v = x.var(dim=axis, keepdim=True, unbiased=False)
    return (x - m) / torch.sqrt(v + eps)
def _scatter_add(tgt, idx, src, axis=0):
    return tgt.clone().index_add_(axis, idx, src)
def _segment_sum(src, seg, n):
    out = torch.zeros((n,) + src.shape[1:], dtype=src.dtype)
    return out.index_add_(0, seg, src)
def _pad(x, pw):
    flat = tuple(v for pair in reversed(pw) for v in pair)
    return torch.nn.functional.pad(x, flat)

kernel_name = 'concat_heads__grouped_kv_mqa__ssm_conv_s4d__prompt'

def setup_inputs():

    _w = (lambda a: (lambda t: t.to(torch.bfloat16) if t.is_floating_point() else t)(torch.as_tensor(a)))
    def _A_setup():
        B, S, D, H = 1, 2048, 512, 32
        Dh = D // H
        return {
            "x": _w((lambda *s: torch.randn(*s, dtype=torch.bfloat16) * 0.05)(B, S, D)),
            "wq": _w((lambda *s: torch.randn(*s, dtype=torch.bfloat16) * 0.8)(D, H * Dh)),
            "wk": _w((lambda *s: torch.randn(*s, dtype=torch.bfloat16) * 0.8)(D, Dh)),
            "wv": _w((lambda *s: torch.randn(*s, dtype=torch.bfloat16) * 0.05)(D, Dh)),
            "wo": _w((lambda *s: torch.randn(*s, dtype=torch.bfloat16) * 0.05)(H * Dh, D)),
        }
    _A_in = _A_setup()

    def _B_setup():
        Bsz, L, D, N = 1, 2048, 512, 128
        return {
            "u": _w((lambda *s: torch.randn(*s, dtype=torch.bfloat16) * 0.05)(Bsz, L, D)),
            "log_A_real": _w((lambda *s: torch.randn(*s, dtype=torch.bfloat16) * 6.4)(D, N) * 0.5),
            "A_imag": _w((lambda *s: torch.randn(*s, dtype=torch.bfloat16) * 0.05)(D, N) * 3.14),
            "C_real": _w((lambda *s: torch.randn(*s, dtype=torch.bfloat16) * 0.05)(D, N) / N ** 0.5),
            "C_imag": _w((lambda *s: torch.randn(*s, dtype=torch.bfloat16) * 0.05)(D, N) / N ** 0.5),
            "log_dt": _w((lambda *s: torch.randn(*s, dtype=torch.bfloat16) * 0.05)(D) * 0.5 - 4.0),
            "D_skip": _w((lambda *s: torch.randn(*s, dtype=torch.bfloat16) * 0.05)(D)),
        }
    _B_in = _B_setup()

    return {
        "A_x": _A_in["x"],
        "A_wq": _A_in["wq"],
        "A_wk": _A_in["wk"],
        "A_wv": _A_in["wv"],
        "A_wo": _A_in["wo"],
        "B_u": _B_in["u"],
        "B_log_A_real": _B_in["log_A_real"],
        "B_A_imag": _B_in["A_imag"],
        "B_C_real": _B_in["C_real"],
        "B_C_imag": _B_in["C_imag"],
        "B_log_dt": _B_in["log_dt"],
        "B_D_skip": _B_in["D_skip"],
    }

def reference(A_x, A_wq, A_wk, A_wv, A_wo, B_u, B_log_A_real, B_A_imag, B_C_real, B_C_imag, B_log_dt, B_D_skip):
    def _A_ref(x, wq, wk, wv, wo):
        B, S, D = x.shape
        H = 32
        Dh = D // H
        q = (lambda x, *d: x.permute(*d))((x @ wq).reshape(B, S, H, Dh), 0, 2, 1, 3)
        k = x @ wk
        v = x @ wv
        scores = torch.einsum("bhqd,bkd->bhqk", q, k) * (Dh ** -0.5)
        p = _softmax(scores, axis=-1)
        o = torch.einsum("bhqk,bkd->bhqd", p, v)
        return (lambda x, *d: x.permute(*d))(o, 0, 2, 1, 3).reshape(B, S, H * Dh) @ wo

    def _B_ref(u, log_A_real, A_imag, C_real, C_imag, log_dt, D_skip):
        L = u.shape[1]
        dt = torch.exp(log_dt)
        A = -torch.exp(log_A_real) + 1j * A_imag
        C = (C_real + 1j * C_imag) * dt[:, None]
        pos = (lambda x, dt: x.to(dt))(torch.arange(L), log_dt.dtype)
        P = torch.exp((A * dt[:, None])[:, :, None] * pos[None, None, :])
        K = 2.0 * torch.einsum("dn,dnl->dl", C, P).real
        L2 = 2 * L
        u_t = (lambda x, *d: x.permute(*d))(u, 0, 2, 1)
        Kf = (lambda x, *a, **k: torch.fft.rfft(x.float(), *a, **k))(K, L2)
        Uf = (lambda x, *a, **k: torch.fft.rfft(x.float(), *a, **k))(u_t, L2)
        y = (lambda x, *a, **k: torch.fft.irfft(x, *a, **k).to(torch.bfloat16))(Uf * Kf[None, :, :], L2)[:, :, :L]
        y = (lambda x, *d: x.permute(*d))(y, 0, 2, 1)
        return y + u * D_skip[None, None, :]

    a = _A_ref(A_x, A_wq, A_wk, A_wv, A_wo)
    b = _B_ref(B_u, B_log_A_real, B_A_imag, B_C_real, B_C_imag, B_log_dt, B_D_skip)
    return torch.concatenate([a, b], axis=-1)
```

```asm
; @launch kernel=concat_heads__grouped_kv_mqa__ssm_conv_s4d__prompt_kernel grid=(256,1,1) block=(768,1,1) lds=155904
.amdgcn_target "amdgcn-amd-amdhsa--gfx950"
.text
.p2align 12
.globl concat_heads__grouped_kv_mqa__ssm_conv_s4d__prompt_kernel
.p2align 8
.type concat_heads__grouped_kv_mqa__ssm_conv_s4d__prompt_kernel,@function
concat_heads__grouped_kv_mqa__ssm_conv_s4d__prompt_kernel:
    s_cmp_ge_u32 s2, 256
    s_cbranch_scc1 F_END
    s_load_dwordx16 s[16:31], s[0:1], 0
    s_load_dwordx8 s[32:39], s[0:1], 64
    s_load_dwordx4 s[40:43], s[0:1], 96
    s_load_dwordx2 s[44:45], s[0:1], 112
    v_lshrrev_b32 v1, 6, v0
    v_and_b32 v0, 63, v0
    v_readfirstlane_b32 s3, v1
    s_and_b32 s4, s2, 7
    s_lshr_b32 s5, s2, 3
    s_lshr_b32 s6, s5, 3
    s_lshl_b32 s7, s4, 2
    s_add_u32 s6, s6, s7
    s_and_b32 s7, s5, 7
    s_lshr_b32 s9, s7, 1
    s_mov_b32 s46, 0x628000
    s_mov_b32 s47, 0x00020000
    s_add_u32 s8, s6, s7
    s_and_b32 s8, s8, 3
    s_lshl_b32 s61, s2, 2
    s_lshl_b32 s62, s2, 9
    s_cmp_eq_u32 s3, 4
    s_cbranch_scc1 F_P
    s_setprio 2
    s_mov_b64 exec, 0
    s_cmp_eq_u32 s3, 0
    s_cbranch_scc1 TCH_0
    s_cmp_eq_u32 s3, 1
    s_cbranch_scc1 TCH_1
    s_cmp_eq_u32 s3, 2
    s_cbranch_scc1 TCH_2
    s_cmp_eq_u32 s3, 3
    s_cbranch_scc1 TCH_3
    s_cmp_eq_u32 s3, 5
    s_cbranch_scc1 TCH_5
    s_cmp_eq_u32 s3, 6
    s_cbranch_scc1 TCH_6
    s_cmp_eq_u32 s3, 7
    s_cbranch_scc1 TCH_7
    s_cmp_eq_u32 s3, 8
    s_cbranch_scc1 TCH_8
    s_cmp_eq_u32 s3, 9
    s_cbranch_scc1 TCH_9
    s_cmp_eq_u32 s3, 10
    s_cbranch_scc1 TCH_10
    s_branch TCH_11
F_P:
    s_setprio 3
    s_lshl_b32 s14, s6, 12
    s_lshr_b32 s15, s9, 1
    s_lshl_b32 s15, s15, 11
    s_add_u32 s14, s14, s15
    s_and_b32 s15, s9, 1
    s_and_b32 s12, s7, 1
    s_add_u32 s11, s12, 8
    s_lshl_b32 s15, s15, s11
    s_lshl_b32 s12, s12, 10
    s_add_u32 s14, s14, s15
    s_add_u32 s14, s14, s12
    v_lshrrev_b32 v3, 5, v0
    s_bitcmp1_b32 s7, 0
    s_cselect_b32 s15, 0, 256
    v_mul_u32_u24 v3, s15, v3
    v_lshl_add_u32 v3, v0, 3, v3
    v_mov_b32 v4, -1
    v_mov_b32 v5, -1
    v_mov_b32 v21, s61
    v_mov_b32 v23, 0x80
    s_and_b32 s15, s2, 3
    s_lshl_b32 s15, s15, 6
    v_lshrrev_b32 v112, 4, v0
    v_and_b32 v113, 15, v0
    v_add_u32 v114, 0, v112
    v_xor_b32 v114, v114, v113
    v_lshlrev_b32 v114, 4, v114
    v_lshl_add_u32 v152, v112, 10, v114
    v_add_u32 v114, 4, v112
    v_xor_b32 v114, v114, v113
    v_lshlrev_b32 v114, 4, v114
    v_lshl_add_u32 v153, v112, 10, v114
    v_add_u32 v153, 3072, v153
    v_add_u32 v114, 8, v112
    v_xor_b32 v114, v114, v113
    v_lshlrev_b32 v114, 4, v114
    v_lshl_add_u32 v154, v112, 10, v114
    v_add_u32 v154, 6144, v154
    v_add_u32 v114, 12, v112
    v_xor_b32 v114, v114, v113
    v_lshlrev_b32 v114, 4, v114
    v_lshl_add_u32 v155, v112, 10, v114
    v_add_u32 v155, 9216, v155
    v_and_b32 v114, 0x27, v0
    v_and_b32 v115, 8, v0
    v_lshl_add_u32 v114, v115, 1, v114
    v_and_b32 v115, 16, v0
    v_lshrrev_b32 v115, 1, v115
    v_add_lshl_u32 v157, v114, v115, 4
    v_mov_b32 v6, 155648
    v_mov_b32 v7, 1
    s_lshl_b32 s10, s6, 16
    s_lshl_b32 s11, s9, 14
    s_add_u32 s10, s10, s11
    s_lshl_b32 s11, s8, 8
    s_add_u32 s10, s10, s11
    s_lshl_b32 s12, s8, 12
    s_lshl_b32 s13, s9, 12
    s_mov_b32 s50, 0x200000
    s_mov_b32 s51, 0x00020000
    s_mov_b32 s58, 0x4000
    s_mov_b32 s59, 0x00020000
    s_bitcmp1_b32 s7, 0
    s_waitcnt lgkmcnt(0)
    s_cselect_b64 s[56:57], s[22:23], s[20:21]
    buffer_store_dwordx2 v[4:5], v3, s[44:47], s14 offen sc1
    s_mov_b64 exec, 1
    global_load_dword v20, v21, s[56:57]
    global_load_dword v20, v21, s[18:19]
    global_load_dword v20, v23, s[42:43]
    global_load_dword v20, v21, s[28:29]
    global_load_dword v20, v21, s[30:31]
    global_load_dword v20, v21, s[32:33]
    global_load_dword v20, v21, s[34:35]
    global_load_dword v20, v21, s[36:37]
    global_load_dword v20, v21, s[38:39]
    s_mov_b64 exec, -1
    s_mov_b64 s[48:49], s[16:17]
    s_mov_b64 s[36:37], s[42:43]
    s_mov_b32 s38, 256
    s_mov_b32 s39, 0x00020000
    s_add_u32 m0, s13, 0
    s_nop 0
    buffer_load_dwordx4 v152, s[48:51], s10 offen offset:0 lds
    buffer_load_dwordx4 v153, s[48:51], s10 offen offset:1024 lds
    buffer_load_dwordx4 v154, s[48:51], s10 offen offset:2048 lds
    buffer_load_dwordx4 v155, s[48:51], s10 offen offset:3072 lds
    s_mov_b32 m0, 131072
    s_nop 0
    buffer_load_dwordx4 v157, s[56:59], s12 offen offset:0 lds
    buffer_load_dwordx4 v157, s[56:59], s12 offen offset:1024 lds
    buffer_load_dwordx4 v157, s[56:59], s12 offen offset:2048 lds
    buffer_load_dwordx4 v157, s[56:59], s12 offen offset:3072 lds
    s_add_u32 s8, s8, 1
    s_and_b32 s11, s8, 3
    s_cselect_b32 s11, 1, -3
    s_lshl_b32 s11, s11, 8
    s_add_u32 s10, s10, s11
    s_lshl_b32 s11, s11, 4
    s_add_u32 s12, s12, s11
    s_barrier
    s_add_u32 m0, s13, 16384
    s_nop 0
    buffer_load_dwordx4 v152, s[48:51], s10 offen offset:0 lds
    v_xor_b32 v16, v112, v113
    buffer_load_dwordx4 v153, s[48:51], s10 offen offset:1024 lds
    v_lshlrev_b32 v16, 4, v16
    buffer_load_dwordx4 v154, s[48:51], s10 offen offset:2048 lds
    v_lshl_add_u32 v16, v113, 8, v16
    buffer_load_dwordx4 v155, s[48:51], s10 offen offset:3072 lds
    v_add_u32 v8, s13, v16
    s_mov_b32 m0, 135168
    s_nop 0
    buffer_load_dwordx4 v157, s[56:59], s12 offen offset:0 lds
    v_xor_b32 v9, 64, v8
    buffer_load_dwordx4 v157, s[56:59], s12 offen offset:1024 lds
    v_xor_b32 v10, 128, v8
    buffer_load_dwordx4 v157, s[56:59], s12 offen offset:2048 lds
    v_xor_b32 v11, 192, v8
    buffer_load_dwordx4 v157, s[56:59], s12 offen offset:3072 lds
    v_lshrrev_b32 v17, 5, v0
    s_add_u32 s8, s8, 1
    s_and_b32 s11, s8, 3
    s_cselect_b32 s11, 1, -3
    s_lshl_b32 s11, s11, 8
    s_add_u32 s10, s10, s11
    s_lshl_b32 s11, s11, 4
    s_add_u32 s12, s12, s11
    ds_write_b32 v6, v7 offset:20
    s_add_u32 m0, s13, 32768
    s_nop 0
    buffer_load_dwordx4 v152, s[48:51], s10 offen offset:0 lds
    v_lshlrev_b32 v16, 9, v17
    buffer_load_dwordx4 v153, s[48:51], s10 offen offset:1024 lds
    v_and_b32 v18, 31, v0
    buffer_load_dwordx4 v154, s[48:51], s10 offen offset:2048 lds
    v_lshl_add_u32 v16, v18, 3, v16
    buffer_load_dwordx4 v155, s[48:51], s10 offen offset:3072 lds
    v_add_u32 v12, 131072, v16
    s_mov_b32 m0, 139264
    s_nop 0
TCH_0:
ST0_1:
    s_cbranch_execz ST0_2
    buffer_load_dwordx4 v157, s[56:59], s12 offen offset:0 lds
    v_and_b32 v18, 1, v112
    buffer_load_dwordx4 v157, s[56:59], s12 offen offset:1024 lds
    v_lshlrev_b32 v16, 4, v113
    buffer_load_dwordx4 v157, s[56:59], s12 offen offset:2048 lds
    v_lshl_add_u32 v16, v17, 9, v16
    buffer_load_dwordx4 v157, s[56:59], s12 offen offset:3072 lds
    v_lshl_add_u32 v13, v18, 3, v16
    s_add_u32 s8, s8, 1
    s_and_b32 s11, s8, 3
    s_cselect_b32 s11, 1, -3
    s_lshl_b32 s11, s11, 8
    s_add_u32 s10, s10, s11
    s_lshl_b32 s11, s11, 4
    s_add_u32 s12, s12, s11
    s_add_u32 m0, s13, 49152
    s_nop 0
    buffer_load_dwordx4 v152, s[48:51], s10 offen offset:0 lds
    v_and_b32 v16, 3, v0
    buffer_load_dwordx4 v153, s[48:51], s10 offen offset:1024 lds
    v_lshlrev_b32 v16, 4, v16
    buffer_load_dwordx4 v154, s[48:51], s10 offen offset:2048 lds
    v_and_b32 v19, 4, v0
    buffer_load_dwordx4 v155, s[48:51], s10 offen offset:3072 lds
    v_lshl_add_u32 v16, v19, 5, v16
    s_mov_b32 m0, 143360
    s_nop 0
    buffer_load_dwordx4 v157, s[56:59], s12 offen offset:0 lds
    v_and_b32 v19, 8, v0
    buffer_load_dwordx4 v157, s[56:59], s12 offen offset:1024 lds
    v_lshl_add_u32 v16, v19, 3, v16
    buffer_load_dwordx4 v157, s[56:59], s12 offen offset:2048 lds
    v_lshl_add_u32 v16, v17, 8, v16
    buffer_load_dwordx4 v157, s[56:59], s12 offen offset:3072 lds
    v_lshl_add_u32 v14, v18, 3, v16
    s_mov_b64 exec, 1
    s_waitcnt vmcnt(41)
    buffer_atomic_add v7, off, s[36:39], s15 sc1
    s_mov_b64 exec, -1
    s_bitcmp1_b32 s7, 0
    s_cbranch_scc1 F_PV
    s_branch F_P2
F_DISP:
    s_mov_b64 exec, -1
    s_waitcnt lgkmcnt(0)
    s_barrier
    s_mov_b64 exec, 0
    s_cmp_eq_u32 s3, 6
    s_cbranch_scc1 TCE_6
    s_cmp_eq_u32 s3, 7
    s_cbranch_scc1 TCE_7
    s_branch TCE_5
F_DE:
    s_mov_b64 exec, -1
    s_cmp_lg_u32 s3, 5
    s_cbranch_scc1 F_I
    s_load_dword s60, s[26:27], s62
    s_load_dword s60, s[24:25], s62
    s_load_dword s60, s[40:41], s62
    s_branch F_I
F_S0:
    s_mov_b64 exec, -1
    s_sub_u32 s64, s3, 8
    s_lshr_b32 s9, s64, 1
    s_and_b32 s10, s64, 1
    s_lshl_b32 s8, s4, 5
    s_add_u32 s8, s8, s5
    s_lshl_b32 s11, s8, 1
    s_add_u32 s11, s11, s9
    s_lshl_b32 s12, s11, 8
    s_lshl_b32 s13, s10, 7
    s_add_u32 s12, s12, s13
    s_lshl_b32 s13, s8, 2
    v_lshlrev_b32 v1, 1, v0
    s_mov_b32 s50, 0x20000
    s_mov_b32 s51, 0x00020000
    s_mov_b32 s54, 0x20000
    s_mov_b32 s55, 0x00020000
    s_mov_b32 s58, 0x20000
    s_mov_b32 s59, 0x00020000
    s_mov_b32 s62, 0x20000
    s_mov_b32 s63, 0x00020000
    s_waitcnt lgkmcnt(0)
    s_mov_b64 s[16:17], s[36:37]
    s_mov_b64 s[20:21], s[38:39]
    s_movk_i32 s18, 0x400
    s_mov_b32 s19, s51
    s_movk_i32 s22, 0x400
    s_mov_b32 s23, s51
    s_lshl_b32 s13, s11, 1
    s_mov_b64 s[48:49], s[28:29]
    s_mov_b64 s[52:53], s[30:31]
    s_mov_b64 s[56:57], s[32:33]
    s_mov_b64 s[60:61], s[34:35]
    s_barrier
    buffer_load_ushort v2, v1, s[48:51], s12 offen
    buffer_load_ushort v3, v1, s[52:55], s12 offen
    buffer_load_ushort v4, v1, s[56:59], s12 offen
    buffer_load_ushort v5, v1, s[60:63], s12 offen
    buffer_load_ushort v18, off, s[16:19], s13
    buffer_load_ushort v19, off, s[20:23], s13
    s_branch F_S
F_L:
    s_mov_b64 exec, -1
    v_lshlrev_b32 v2, 2, v0
    v_and_b32 v2, 255, v2
    v_mov_b32 v8, 0
    v_add_u32 v2, 155648, v2
    ds_write_b32 v2, v8
    v_lshrrev_b32 v112, 4, v0
    v_and_b32 v113, 15, v0
    s_lshl_b32 s14, s3, 2
    v_add_u32 v114, s14, v112
    v_xor_b32 v114, v114, v113
    v_lshlrev_b32 v114, 4, v114
    v_lshl_add_u32 v157, v112, 10, v114
    v_bfe_u32 v114, v0, 4, 1
    v_lshlrev_b32 v114, 2, v114
    v_and_b32 v115, 7, v0
    v_xor_b32 v114, v114, v115
    v_lshlrev_b32 v114, 4, v114
    v_lshrrev_b32 v115, 3, v0
    v_lshl_add_u32 v152, v115, 10, v114
    v_add_u32 v153, 7168, v152
    v_add_u32 v154, 14336, v152
    v_add_u32 v155, 21504, v152
    s_add_u32 s14, s14, 155648
    v_mov_b32 v158, s14
    s_add_u32 s14, s3, 155648
    v_mov_b32 v125, s14
    v_mov_b32 v142, 1
    v_mov_b32 v6, 155648
    s_lshl_b32 s10, s6, 16
    s_lshl_b32 s13, s3, 12
    s_add_u32 s10, s10, s13
    s_lshl_b32 s14, s8, 8
    s_add_u32 s10, s10, s14
    s_lshl_b32 s14, s3, 10
    s_add_u32 s15, s9, 1
    s_and_b32 s15, s15, 3
    s_lshl_b32 s56, s15, 14
    s_add_u32 s56, s56, s10
    s_lshl_b32 s60, s15, 12
    s_add_u32 s60, s60, s14
    s_add_u32 s15, s9, 2
    s_and_b32 s15, s15, 3
    s_lshl_b32 s57, s15, 14
    s_add_u32 s57, s57, s10
    s_lshl_b32 s61, s15, 12
    s_add_u32 s61, s61, s14
    s_add_u32 s15, s9, 3
    s_and_b32 s15, s15, 3
    s_lshl_b32 s58, s15, 14
    s_add_u32 s58, s58, s10
    s_lshl_b32 s62, s15, 12
    s_add_u32 s62, s62, s14
    s_lshl_b32 s11, s3, 15
    s_lshl_b32 s12, s7, 7
    s_add_u32 s11, s11, s12
    s_lshl_b32 s12, s8, 17
    s_add_u32 s11, s11, s12
    s_mov_b32 s50, 0x200000
    s_mov_b32 s51, 0x00020000
    s_mov_b32 s54, 0x80000
    s_mov_b32 s55, 0x00020000
    s_waitcnt lgkmcnt(0)
    s_mov_b64 s[48:49], s[16:17]
    s_mov_b64 s[52:53], s[18:19]
    s_mov_b64 s[36:37], s[42:43]
    s_mov_b32 s38, 256
    s_mov_b32 s39, 0x00020000
    s_barrier
    v_and_b32 v144, 27, v0
    v_cmp_eq_u32 vcc, 16, v144
    v_mov_b32 v145, 0x3f803f80
    s_and_b32 s64, s3, 3
    s_lshl_b32 s65, s64, 15
    v_cndmask_b32 v144, 0, v145, vcc
    v_lshlrev_b32 v146, 4, v0
    v_add_u32 v1, s65, v146
    v_and_b32 v147, 15, v0
    v_lshlrev_b32 v147, 4, v147
    v_lshrrev_b32 v145, 5, v0
    v_lshl_add_u32 v147, v145, 8, v147
    v_add_u32 v2, s65, v147
    s_lshl_b32 s65, s64, 11
    s_add_u32 s65, s65, 147456
    v_add_u32 v4, s65, v146
    v_add_u32 v5, s65, v147
    s_xor_b32 s65, s3, 3
    s_lshl_b32 s65, s65, 11
    v_add_u32 v160, s65, v146
    v_xor_b32 v161, 2048, v160
    v_xor_b32 v162, 4096, v160
    v_xor_b32 v163, 6144, v160
    v_lshrrev_b32 v164, 2, v160
    v_lshrrev_b32 v165, 2, v161
ST0_2:
    s_cbranch_execz F_L
    v_lshrrev_b32 v166, 2, v162
    v_lshrrev_b32 v167, 2, v163
    v_mov_b32 v156, 0xdddddddd
    v_mov_b32 v72, v144
    v_mov_b32 v73, v144
    v_mov_b32 v74, v144
    v_mov_b32 v75, v144
    v_mov_b32 v76, v144
    v_mov_b32 v77, v144
    v_mov_b32 v78, v144
    v_mov_b32 v79, v144
    v_mov_b32 v80, v144
    v_mov_b32 v81, v144
    v_mov_b32 v82, v144
    v_mov_b32 v83, v144
    v_mov_b32 v84, v144
    v_mov_b32 v85, v144
    v_mov_b32 v86, v144
    v_mov_b32 v87, v144
    v_mov_b32 v88, v144
    v_mov_b32 v89, v144
    v_mov_b32 v90, v144
    v_mov_b32 v91, v144
    v_mov_b32 v92, v144
    v_mov_b32 v93, v144
    v_mov_b32 v94, v144
    v_mov_b32 v95, v144
    v_mov_b32 v8, 0
    v_mov_b32 v9, 0
    v_mov_b32 v10, 0
    v_mov_b32 v11, 0
    v_mov_b32 v12, 0
    v_mov_b32 v13, 0
    v_mov_b32 v14, 0
    v_mov_b32 v15, 0
    v_mov_b32 v16, 0
    v_mov_b32 v17, 0
    v_mov_b32 v18, 0
    v_mov_b32 v19, 0
    v_mov_b32 v20, 0
    v_mov_b32 v21, 0
    v_mov_b32 v22, 0
    v_mov_b32 v23, 0
    v_mov_b32 v24, 0
    v_mov_b32 v25, 0
    v_mov_b32 v26, 0
    v_mov_b32 v27, 0
    v_mov_b32 v28, 0
    v_mov_b32 v29, 0
    v_mov_b32 v30, 0
    v_mov_b32 v31, 0
    v_mov_b32 v32, 0
    v_mov_b32 v33, 0
    v_mov_b32 v34, 0
    v_mov_b32 v35, 0
    v_mov_b32 v36, 0
    v_mov_b32 v37, 0
    v_mov_b32 v38, 0
    v_mov_b32 v39, 0
    v_mov_b32 v40, 0
    v_mov_b32 v41, 0
    v_mov_b32 v42, 0
    v_mov_b32 v43, 0
    v_mov_b32 v44, 0
    v_mov_b32 v45, 0
    v_mov_b32 v46, 0
    v_mov_b32 v47, 0
    v_mov_b32 v48, 0
    v_mov_b32 v49, 0
    v_mov_b32 v50, 0
    v_mov_b32 v51, 0
    v_mov_b32 v52, 0
    v_mov_b32 v53, 0
    v_mov_b32 v54, 0
    v_mov_b32 v55, 0
    v_mov_b32 v56, 0
    v_mov_b32 v57, 0
    v_mov_b32 v58, 0
    v_mov_b32 v59, 0
    v_mov_b32 v60, 0
    v_mov_b32 v61, 0
    v_mov_b32 v62, 0
    v_mov_b32 v63, 0
    v_mov_b32 v64, 0
    v_mov_b32 v65, 0
    v_mov_b32 v66, 0
    v_mov_b32 v67, 0
    v_mov_b32 v68, 0
    v_mov_b32 v69, 0
    v_mov_b32 v70, 0
    v_mov_b32 v71, 0
    s_and_b32 s66, s5, 3
    s_lshl_b32 s66, s66, 13
    s_mov_b32 s68, 0x0000ffff
    s_mov_b32 s69, 0x0000ffff
    v_lshrrev_b32 v114, 2, v0
    v_lshlrev_b32 v114, 11, v114
    v_and_b32 v115, 3, v0
    v_mul_u32_u24 v115, 448, v115
    s_lshl_b32 s65, s3, 15
    s_add_u32 s65, s65, 256
    v_add3_u32 v3, v114, v115, s65
    v_lshlrev_b32 v7, 7, v0
    v_and_b32 v124, 3, v0
    v_lshlrev_b32 v124, 6, v124
    s_mov_b32 s59, 400000
F_LPI:
    ds_read_b32 v121, v6 offset:20
    s_waitcnt lgkmcnt(0)
    v_readfirstlane_b32 s15, v121
    s_sub_u32 s59, s59, 1
    s_cselect_b32 s15, 1, s15
    s_cmp_lt_u32 s15, 1
    s_cbranch_scc1 F_LPI
    s_add_u32 m0, s13, 65536
    s_nop 0
    buffer_load_dwordx4 v152, s[52:55], s11 offen offset:0 lds
    buffer_load_dwordx4 v153, s[52:55], s11 offen offset:1024 lds
    buffer_load_dwordx4 v154, s[52:55], s11 offen offset:2048 lds
    buffer_load_dwordx4 v155, s[52:55], s11 offen offset:3072 lds
    s_add_u32 m0, s60, 0
    s_nop 0
    buffer_load_dwordx4 v157, s[48:51], s56 offen lds
    s_add_u32 m0, s61, 0
    s_nop 0
    buffer_load_dwordx4 v157, s[48:51], s57 offen lds
    s_add_u32 m0, s62, 0
    s_nop 0
    buffer_load_dwordx4 v157, s[48:51], s58 offen lds
    s_add_u32 s8, s8, 1
    s_and_b32 s12, s8, 3
    s_cselect_b32 s12, 1, -3
    s_lshl_b32 s12, s12, 8
    s_add_u32 s56, s56, s12
    s_add_u32 s57, s57, s12
    s_add_u32 s58, s58, s12
    s_lshl_b32 s12, s12, 9
    s_add_u32 s11, s11, s12
    s_mov_b32 s59, 400000
F_LPG:
    ds_read_b32 v121, v6 offset:16
    s_waitcnt lgkmcnt(0)
    v_readfirstlane_b32 s15, v121
    s_sub_u32 s59, s59, 1
    s_cselect_b32 s15, 1, s15
    s_cmp_lt_u32 s15, 1
    s_cbranch_scc1 F_LPG
    v_mov_b32 v159, 1
    s_waitcnt vmcnt(0)
    ds_write_b8 v125, v159
    s_add_u32 m0, s60, 16384
    s_nop 0
    buffer_load_dwordx4 v157, s[48:51], s56 offen lds
    s_add_u32 m0, s61, 16384
    s_nop 0
    buffer_load_dwordx4 v157, s[48:51], s57 offen lds
    s_add_u32 m0, s62, 16384
    s_nop 0
    buffer_load_dwordx4 v157, s[48:51], s58 offen lds
    s_add_u32 m0, s13, 81920
    s_nop 0
    buffer_load_dwordx4 v152, s[52:55], s11 offen offset:0 lds
    buffer_load_dwordx4 v153, s[52:55], s11 offen offset:1024 lds
    buffer_load_dwordx4 v154, s[52:55], s11 offen offset:2048 lds
    buffer_load_dwordx4 v155, s[52:55], s11 offen offset:3072 lds
    s_add_u32 s8, s8, 1
    s_and_b32 s12, s8, 3
    s_cselect_b32 s12, 1, -3
    s_lshl_b32 s12, s12, 8
    s_add_u32 s56, s56, s12
    s_add_u32 s57, s57, s12
    s_add_u32 s58, s58, s12
    s_lshl_b32 s12, s12, 9
    s_add_u32 s11, s11, s12
    s_add_u32 m0, s60, 32768
    s_nop 0
    buffer_load_dwordx4 v157, s[48:51], s56 offen lds
    s_add_u32 m0, s61, 32768
    s_nop 0
    buffer_load_dwordx4 v157, s[48:51], s57 offen lds
    s_add_u32 m0, s62, 32768
    s_nop 0
    buffer_load_dwordx4 v157, s[48:51], s58 offen lds
    s_add_u32 m0, s13, 98304
    s_nop 0
    buffer_load_dwordx4 v152, s[52:55], s11 offen offset:0 lds
    buffer_load_dwordx4 v153, s[52:55], s11 offen offset:1024 lds
    buffer_load_dwordx4 v154, s[52:55], s11 offen offset:2048 lds
    buffer_load_dwordx4 v155, s[52:55], s11 offen offset:3072 lds
    s_add_u32 s8, s8, 1
    s_and_b32 s12, s8, 3
    s_cselect_b32 s12, 1, -3
    s_lshl_b32 s12, s12, 8
    s_add_u32 s56, s56, s12
    s_add_u32 s57, s57, s12
    s_add_u32 s58, s58, s12
    s_lshl_b32 s12, s12, 9
    s_add_u32 s11, s11, s12
    s_add_u32 m0, s60, 49152
    s_nop 0
    buffer_load_dwordx4 v157, s[48:51], s56 offen lds
    s_add_u32 m0, s61, 49152
    s_nop 0
    buffer_load_dwordx4 v157, s[48:51], s57 offen lds
    s_add_u32 m0, s62, 49152
    s_nop 0
    buffer_load_dwordx4 v157, s[48:51], s58 offen lds
    s_add_u32 m0, s13, 114688
    s_nop 0
TCH_1:
ST0_3:
    s_cbranch_execz F_L
    buffer_load_dwordx4 v152, s[52:55], s11 offen offset:0 lds
    buffer_load_dwordx4 v153, s[52:55], s11 offen offset:1024 lds
    buffer_load_dword v121, v124, s[36:39], 0 offen sc1
    v_mov_b32 v159, 3
    s_waitcnt vmcnt(13)
    ds_write_b8 v125, v159
    buffer_load_dwordx4 v154, s[52:55], s11 offen offset:2048 lds
    buffer_load_dwordx4 v155, s[52:55], s11 offen offset:3072 lds
    s_setprio 3
    v_mov_b32 v159, 7
    s_waitcnt vmcnt(8)
    ds_write_b8 v125, v159
    s_waitcnt vmcnt(2)
    v_cmp_ne_u32 vcc, 64, v121
    buffer_load_dword v120, v3, s[44:47], 0 offen sc1
    buffer_load_dwordx4 v[112:115], v1, s[44:47], s66 offen offset:0 sc1
    buffer_load_dwordx4 v[116:119], v1, s[44:47], s66 offen offset:1024 sc1
    v_mov_b32 v159, 15
    s_waitcnt vmcnt(3)
    ds_write_b8 v125, v159
    s_mov_b32 s14, 200000
    s_cmp_eq_u64 vcc, 0
    s_cbranch_scc1 F_KW
F_POLL:
    buffer_load_dword v121, v124, s[36:39], 0 offen sc1
    s_waitcnt vmcnt(0)
    v_cmp_ne_u32 vcc, 64, v121
    s_cmp_eq_u64 vcc, 0
    s_cbranch_scc1 F_POK
    s_sub_u32 s14, s14, 1
    s_cbranch_scc0 F_POLL
F_POK:
    s_mov_b32 s14, 200000
F_KV:
    buffer_load_dword v120, v3, s[44:47], 0 offen sc1
    buffer_load_dwordx4 v[112:115], v1, s[44:47], s66 offen offset:0 sc1
    buffer_load_dwordx4 v[116:119], v1, s[44:47], s66 offen offset:1024 sc1
F_KW:
    s_waitcnt vmcnt(0)
    ds_write_b128 v4, v[112:115] offset:0
    ds_write_b128 v4, v[116:119] offset:1024
    v_max3_u32 v120, v112, v113, v120
    v_max3_u32 v120, v114, v115, v120
    v_max3_u32 v120, v116, v117, v120
    v_max3_u32 v120, v118, v119, v120
    v_cmp_eq_u32 vcc, -1, v120
    s_cmp_eq_u64 vcc, 0
    s_cbranch_scc1 F_KOK
    s_sub_u32 s14, s14, 1
    s_waitcnt lgkmcnt(0)
    s_cbranch_scc0 F_KV
F_KOK:
    v_mov_b32 v157, v158
    s_waitcnt lgkmcnt(0)
    ds_write_b32 v157, v159 offset:80
    s_branch F_BQ
F_GS2:
    s_mov_b32 s58, 400000
F_GT2:
    ds_read_b64 v[12:13], v8
    s_sub_u32 s58, s58, 1
    s_waitcnt lgkmcnt(0)
    s_cbranch_scc1 F_GC2
    v_readfirstlane_b32 s57, v12
    s_andn2_b32 s57, 0x02020202, s57
    s_cbranch_scc1 F_GT2
    s_branch F_GC2
F_GS3:
    s_mov_b32 s58, 400000
F_GT3:
    ds_read_b64 v[12:13], v8
    s_sub_u32 s58, s58, 1
    s_waitcnt lgkmcnt(0)
    s_cbranch_scc1 F_GC3
    v_readfirstlane_b32 s57, v12
    s_andn2_b32 s57, 0x04040404, s57
    s_cbranch_scc1 F_GT3
    s_branch F_GC3
F_GS4:
    s_mov_b32 s58, 400000
F_GT4:
    ds_read_b64 v[12:13], v8
    s_sub_u32 s58, s58, 1
    s_waitcnt lgkmcnt(0)
    s_cbranch_scc1 F_GC4
    v_and_b32 v12, v12, v13
    s_nop 0
    v_readfirstlane_b32 s57, v12
    s_andn2_b32 s57, 0x08080808, s57
    s_cbranch_scc1 F_GT4
    s_branch F_GC4
F_GKS:
    s_mov_b32 s58, 400000
F_GKF:
    ds_read_b32 v142, v157 offset:64
    s_waitcnt lgkmcnt(0)
    v_readfirstlane_b32 s57, v142
    s_sub_u32 s58, s58, 1
    s_cselect_b32 s57, 1, s57
    s_cmp_lt_u32 s57, 1
    s_cbranch_scc1 F_GKF
    v_mov_b32 v142, 1
    s_sub_u32 s66, s66, 4096
    s_waitcnt vmcnt(0)
    s_branch F_BQ
F_P2:
    s_mov_b32 s15, 0x3eb8aa3b
    s_waitcnt vmcnt(25)
    ds_read_b64_tr_b16 v[112:113], v12 offset:0
    ds_read_b64_tr_b16 v[114:115], v12 offset:256
    ds_read_b128 v[116:119], v8 offset:0
    ds_read_b64_tr_b16 v[120:121], v12 offset:1024
    ds_read_b64_tr_b16 v[122:123], v12 offset:1280
    ds_read_b128 v[124:127], v9 offset:0
    ds_read_b64_tr_b16 v[128:129], v12 offset:2048
    ds_read_b64_tr_b16 v[130:131], v12 offset:2304
    ds_read_b128 v[132:135], v10 offset:0
    ds_read_b64_tr_b16 v[136:137], v12 offset:3072
    ds_read_b64_tr_b16 v[138:139], v12 offset:3328
    ds_read_b128 v[140:143], v11 offset:0
    s_waitcnt lgkmcnt(9)
    v_mfma_f32_16x16x32_bf16 v[96:99], v[112:115], v[116:119], 0
    s_waitcnt vmcnt(17)
    ds_read_b64_tr_b16 v[144:145], v12 offset:4096
    ds_read_b64_tr_b16 v[146:147], v12 offset:4352
    ds_read_b128 v[148:151], v8 offset:16384
    s_waitcnt lgkmcnt(9)
    v_mfma_f32_16x16x32_bf16 v[100:103], v[120:123], v[124:127], 0
    ds_read_b64_tr_b16 v[112:113], v12 offset:5120
    ds_read_b64_tr_b16 v[114:115], v12 offset:5376
    ds_read_b128 v[116:119], v9 offset:16384
    s_waitcnt lgkmcnt(9)
    v_mfma_f32_16x16x32_bf16 v[96:99], v[128:131], v[132:135], v[96:99]
    ds_read_b64_tr_b16 v[120:121], v12 offset:6144
    ds_read_b64_tr_b16 v[122:123], v12 offset:6400
    ds_read_b128 v[124:127], v10 offset:16384
    s_waitcnt lgkmcnt(9)
    v_mfma_f32_16x16x32_bf16 v[100:103], v[136:139], v[140:143], v[100:103]
    ds_read_b64_tr_b16 v[128:129], v12 offset:7168
    ds_read_b64_tr_b16 v[130:131], v12 offset:7424
    ds_read_b128 v[132:135], v11 offset:16384
    s_waitcnt lgkmcnt(9)
    v_mfma_f32_16x16x32_bf16 v[96:99], v[144:147], v[148:151], v[96:99]
    s_waitcnt vmcnt(9)
    ds_read_b64_tr_b16 v[136:137], v12 offset:8192
    ds_read_b64_tr_b16 v[138:139], v12 offset:8448
    ds_read_b128 v[140:143], v8 offset:32768
    s_waitcnt lgkmcnt(9)
    v_mfma_f32_16x16x32_bf16 v[100:103], v[112:115], v[116:119], v[100:103]
    ds_read_b64_tr_b16 v[144:145], v12 offset:9216
    ds_read_b64_tr_b16 v[146:147], v12 offset:9472
    ds_read_b128 v[148:151], v9 offset:32768
    s_waitcnt lgkmcnt(9)
    v_mfma_f32_16x16x32_bf16 v[96:99], v[120:123], v[124:127], v[96:99]
    ds_read_b64_tr_b16 v[112:113], v12 offset:10240
    ds_read_b64_tr_b16 v[114:115], v12 offset:10496
    ds_read_b128 v[116:119], v10 offset:32768
    s_waitcnt lgkmcnt(9)
    v_mfma_f32_16x16x32_bf16 v[100:103], v[128:131], v[132:135], v[100:103]
    ds_read_b64_tr_b16 v[120:121], v12 offset:11264
    ds_read_b64_tr_b16 v[122:123], v12 offset:11520
    ds_read_b128 v[124:127], v11 offset:32768
    s_waitcnt lgkmcnt(9)
    v_mfma_f32_16x16x32_bf16 v[96:99], v[136:139], v[140:143], v[96:99]
    s_waitcnt vmcnt(1)
    ds_read_b64_tr_b16 v[128:129], v12 offset:12288
    ds_read_b64_tr_b16 v[130:131], v12 offset:12544
    ds_read_b128 v[132:135], v8 offset:49152
    s_waitcnt lgkmcnt(9)
    v_mfma_f32_16x16x32_bf16 v[100:103], v[144:147], v[148:151], v[100:103]
    ds_read_b64_tr_b16 v[136:137], v12 offset:13312
    ds_read_b64_tr_b16 v[138:139], v12 offset:13568
    ds_read_b128 v[140:143], v9 offset:49152
    s_waitcnt lgkmcnt(9)
    v_mfma_f32_16x16x32_bf16 v[96:99], v[112:115], v[116:119], v[96:99]
    ds_read_b64_tr_b16 v[144:145], v12 offset:14336
    ds_read_b64_tr_b16 v[146:147], v12 offset:14592
    ds_read_b128 v[148:151], v10 offset:49152
    s_waitcnt lgkmcnt(9)
    v_mfma_f32_16x16x32_bf16 v[100:103], v[120:123], v[124:127], v[100:103]
TCH_2:
ST0_4:
    s_cbranch_execz F_L
    ds_read_b64_tr_b16 v[112:113], v12 offset:15360
    ds_read_b64_tr_b16 v[114:115], v12 offset:15616
    ds_read_b128 v[116:119], v11 offset:49152
    s_waitcnt lgkmcnt(9)
    v_mfma_f32_16x16x32_bf16 v[96:99], v[128:131], v[132:135], v[96:99]
    s_waitcnt lgkmcnt(6)
    v_mfma_f32_16x16x32_bf16 v[100:103], v[136:139], v[140:143], v[100:103]
    s_waitcnt lgkmcnt(3)
    v_mfma_f32_16x16x32_bf16 v[96:99], v[144:147], v[148:151], v[96:99]
    s_waitcnt lgkmcnt(0)
    v_mfma_f32_16x16x32_bf16 v[100:103], v[112:115], v[116:119], v[100:103]
    ds_write_b32 v6, v7 offset:16
    s_nop 6
    v_add_f32 v96, v96, v100
    v_add_f32 v97, v97, v101
    v_add_f32 v98, v98, v102
    v_add_f32 v99, v99, v103
    v_mul_f32 v96, s15, v96
    v_mul_f32 v97, s15, v97
    v_mul_f32 v98, s15, v98
    v_mul_f32 v99, s15, v99
    v_mov_b32 v14, v13
    s_branch F_PST
F_PV:
    s_waitcnt vmcnt(25)
    ds_read_b64_tr_b16 v[112:113], v12 offset:0
    ds_read_b64_tr_b16 v[114:115], v12 offset:256
    ds_read_b128 v[116:119], v8 offset:0
    ds_read_b64_tr_b16 v[120:121], v12 offset:1024
    ds_read_b64_tr_b16 v[122:123], v12 offset:1280
    ds_read_b128 v[124:127], v9 offset:0
    ds_read_b64_tr_b16 v[128:129], v12 offset:2048
    ds_read_b64_tr_b16 v[130:131], v12 offset:2304
    ds_read_b128 v[132:135], v10 offset:0
    ds_read_b64_tr_b16 v[136:137], v12 offset:3072
    ds_read_b64_tr_b16 v[138:139], v12 offset:3328
    ds_read_b128 v[140:143], v11 offset:0
    s_waitcnt lgkmcnt(9)
    v_mfma_f32_16x16x32_bf16 v[96:99], v[116:119], v[112:115], 0
    s_waitcnt vmcnt(17)
    ds_read_b64_tr_b16 v[144:145], v12 offset:4096
    ds_read_b64_tr_b16 v[146:147], v12 offset:4352
    ds_read_b128 v[148:151], v8 offset:16384
    s_waitcnt lgkmcnt(9)
    v_mfma_f32_16x16x32_bf16 v[100:103], v[124:127], v[120:123], 0
    ds_read_b64_tr_b16 v[112:113], v12 offset:5120
    ds_read_b64_tr_b16 v[114:115], v12 offset:5376
    ds_read_b128 v[116:119], v9 offset:16384
    s_waitcnt lgkmcnt(9)
    v_mfma_f32_16x16x32_bf16 v[96:99], v[132:135], v[128:131], v[96:99]
    ds_read_b64_tr_b16 v[120:121], v12 offset:6144
    ds_read_b64_tr_b16 v[122:123], v12 offset:6400
    ds_read_b128 v[124:127], v10 offset:16384
    s_waitcnt lgkmcnt(9)
    v_mfma_f32_16x16x32_bf16 v[100:103], v[140:143], v[136:139], v[100:103]
    ds_read_b64_tr_b16 v[128:129], v12 offset:7168
    ds_read_b64_tr_b16 v[130:131], v12 offset:7424
    ds_read_b128 v[132:135], v11 offset:16384
    s_waitcnt lgkmcnt(9)
    v_mfma_f32_16x16x32_bf16 v[96:99], v[148:151], v[144:147], v[96:99]
    s_waitcnt vmcnt(9)
    ds_read_b64_tr_b16 v[136:137], v12 offset:8192
    ds_read_b64_tr_b16 v[138:139], v12 offset:8448
    ds_read_b128 v[140:143], v8 offset:32768
    s_waitcnt lgkmcnt(9)
    v_mfma_f32_16x16x32_bf16 v[100:103], v[116:119], v[112:115], v[100:103]
    ds_read_b64_tr_b16 v[144:145], v12 offset:9216
    ds_read_b64_tr_b16 v[146:147], v12 offset:9472
    ds_read_b128 v[148:151], v9 offset:32768
    s_waitcnt lgkmcnt(9)
    v_mfma_f32_16x16x32_bf16 v[96:99], v[124:127], v[120:123], v[96:99]
    ds_read_b64_tr_b16 v[112:113], v12 offset:10240
    ds_read_b64_tr_b16 v[114:115], v12 offset:10496
    ds_read_b128 v[116:119], v10 offset:32768
    s_waitcnt lgkmcnt(9)
    v_mfma_f32_16x16x32_bf16 v[100:103], v[132:135], v[128:131], v[100:103]
    ds_read_b64_tr_b16 v[120:121], v12 offset:11264
    ds_read_b64_tr_b16 v[122:123], v12 offset:11520
    ds_read_b128 v[124:127], v11 offset:32768
    s_waitcnt lgkmcnt(9)
    v_mfma_f32_16x16x32_bf16 v[96:99], v[140:143], v[136:139], v[96:99]
    s_waitcnt vmcnt(1)
    ds_read_b64_tr_b16 v[128:129], v12 offset:12288
    ds_read_b64_tr_b16 v[130:131], v12 offset:12544
    ds_read_b128 v[132:135], v8 offset:49152
    s_waitcnt lgkmcnt(9)
    v_mfma_f32_16x16x32_bf16 v[100:103], v[148:151], v[144:147], v[100:103]
    ds_read_b64_tr_b16 v[136:137], v12 offset:13312
    ds_read_b64_tr_b16 v[138:139], v12 offset:13568
    ds_read_b128 v[140:143], v9 offset:49152
    s_waitcnt lgkmcnt(9)
    v_mfma_f32_16x16x32_bf16 v[96:99], v[116:119], v[112:115], v[96:99]
    ds_read_b64_tr_b16 v[144:145], v12 offset:14336
    ds_read_b64_tr_b16 v[146:147], v12 offset:14592
    ds_read_b128 v[148:151], v10 offset:49152
    s_waitcnt lgkmcnt(9)
    v_mfma_f32_16x16x32_bf16 v[100:103], v[124:127], v[120:123], v[100:103]
    ds_read_b64_tr_b16 v[112:113], v12 offset:15360
    ds_read_b64_tr_b16 v[114:115], v12 offset:15616
    ds_read_b128 v[116:119], v11 offset:49152
    s_waitcnt lgkmcnt(9)
    v_mfma_f32_16x16x32_bf16 v[96:99], v[132:135], v[128:131], v[96:99]
    s_waitcnt lgkmcnt(6)
    v_mfma_f32_16x16x32_bf16 v[100:103], v[140:143], v[136:139], v[100:103]
    s_waitcnt lgkmcnt(3)
    v_mfma_f32_16x16x32_bf16 v[96:99], v[148:151], v[144:147], v[96:99]
    s_waitcnt lgkmcnt(0)
    v_mfma_f32_16x16x32_bf16 v[100:103], v[116:119], v[112:115], v[100:103]
    ds_write_b32 v6, v7 offset:16
    s_nop 6
    v_add_f32 v96, v96, v100
    v_add_f32 v97, v97, v101
    v_add_f32 v98, v98, v102
    v_add_f32 v99, v99, v103
F_PST:
    v_cvt_pk_bf16_f32 v96, v96, v97
    v_cvt_pk_bf16_f32 v97, v98, v99
    v_min_u32 v96, -2, v96
    v_min_u32 v97, -2, v97
    buffer_store_dwordx2 v[96:97], v14, s[44:47], s14 offen sc1
F_I:
    v_and_b32 v144, 27, v0
    v_cmp_eq_u32 vcc, 16, v144
    v_mov_b32 v145, 0x3f803f80
    s_and_b32 s64, s3, 3
    s_lshl_b32 s65, s64, 15
    v_cndmask_b32 v144, 0, v145, vcc
    v_lshlrev_b32 v146, 4, v0
    v_add_u32 v1, s65, v146
    v_and_b32 v147, 15, v0
    v_lshlrev_b32 v147, 4, v147
    v_lshrrev_b32 v145, 5, v0
    v_lshl_add_u32 v147, v145, 8, v147
    v_add_u32 v2, s65, v147
    s_lshl_b32 s65, s64, 11
    s_add_u32 s65, s65, 147456
    v_add_u32 v4, s65, v146
    v_add_u32 v5, s65, v147
    s_xor_b32 s65, s3, 3
    s_lshl_b32 s65, s65, 11
    v_add_u32 v160, s65, v146
    v_xor_b32 v161, 2048, v160
    v_xor_b32 v162, 4096, v160
    v_xor_b32 v163, 6144, v160
    v_lshrrev_b32 v164, 2, v160
    v_lshrrev_b32 v165, 2, v161
    v_lshrrev_b32 v166, 2, v162
    v_lshrrev_b32 v167, 2, v163
    v_mov_b32 v156, 0xdddddddd
    v_mov_b32 v72, v144
    v_mov_b32 v73, v144
    v_mov_b32 v74, v144
    v_mov_b32 v75, v144
    v_mov_b32 v76, v144
    v_mov_b32 v77, v144
    v_mov_b32 v78, v144
    v_mov_b32 v79, v144
    v_mov_b32 v80, v144
    v_mov_b32 v81, v144
    v_mov_b32 v82, v144
    v_mov_b32 v83, v144
    v_mov_b32 v84, v144
    v_mov_b32 v85, v144
    v_mov_b32 v86, v144
    v_mov_b32 v87, v144
    v_mov_b32 v88, v144
    v_mov_b32 v89, v144
    v_mov_b32 v90, v144
    v_mov_b32 v91, v144
    v_mov_b32 v92, v144
TCH_3:
ST0_5:
    s_cbranch_execz F_L
    v_mov_b32 v93, v144
    v_mov_b32 v94, v144
    v_mov_b32 v95, v144
    v_mov_b32 v8, 0
    v_mov_b32 v9, 0
    v_mov_b32 v10, 0
    v_mov_b32 v11, 0
    v_mov_b32 v12, 0
    v_mov_b32 v13, 0
    v_mov_b32 v14, 0
    v_mov_b32 v15, 0
    v_mov_b32 v16, 0
    v_mov_b32 v17, 0
    v_mov_b32 v18, 0
    v_mov_b32 v19, 0
    v_mov_b32 v20, 0
    v_mov_b32 v21, 0
    v_mov_b32 v22, 0
    v_mov_b32 v23, 0
    v_mov_b32 v24, 0
    v_mov_b32 v25, 0
    v_mov_b32 v26, 0
    v_mov_b32 v27, 0
    v_mov_b32 v28, 0
    v_mov_b32 v29, 0
    v_mov_b32 v30, 0
    v_mov_b32 v31, 0
    v_mov_b32 v32, 0
    v_mov_b32 v33, 0
    v_mov_b32 v34, 0
    v_mov_b32 v35, 0
    v_mov_b32 v36, 0
    v_mov_b32 v37, 0
    v_mov_b32 v38, 0
    v_mov_b32 v39, 0
    v_mov_b32 v40, 0
    v_mov_b32 v41, 0
    v_mov_b32 v42, 0
    v_mov_b32 v43, 0
    v_mov_b32 v44, 0
    v_mov_b32 v45, 0
    v_mov_b32 v46, 0
    v_mov_b32 v47, 0
    v_mov_b32 v48, 0
    v_mov_b32 v49, 0
    v_mov_b32 v50, 0
    v_mov_b32 v51, 0
    v_mov_b32 v52, 0
    v_mov_b32 v53, 0
    v_mov_b32 v54, 0
    v_mov_b32 v55, 0
    v_mov_b32 v56, 0
    v_mov_b32 v57, 0
    v_mov_b32 v58, 0
    v_mov_b32 v59, 0
    v_mov_b32 v60, 0
    v_mov_b32 v61, 0
    v_mov_b32 v62, 0
    v_mov_b32 v63, 0
    v_mov_b32 v64, 0
    v_mov_b32 v65, 0
    v_mov_b32 v66, 0
    v_mov_b32 v67, 0
    v_mov_b32 v68, 0
    v_mov_b32 v69, 0
    v_mov_b32 v70, 0
    v_mov_b32 v71, 0
    s_and_b32 s66, s5, 3
    s_lshl_b32 s66, s66, 13
    s_mov_b32 s68, 0x0000ffff
    s_mov_b32 s69, 0x0000ffff
F_G:
    s_setprio 3
    s_and_b32 s14, s3, 1
    s_bfe_u32 s15, s3, 0x10001
    v_and_b32 v113, 15, v0
    v_and_b32 v114, 31, v0
    s_lshl_b32 s56, s14, 5
    v_add_u32 v114, s56, v114
    v_lshrrev_b32 v115, 5, v0
    v_xor_b32 v116, v115, v113
    v_lshlrev_b32 v116, 4, v116
    v_lshl_add_u32 v152, v114, 8, v116
    v_xor_b32 v153, 32, v152
    v_xor_b32 v154, 64, v152
    v_xor_b32 v155, 96, v152
    v_xor_b32 v157, 128, v152
    v_xor_b32 v158, 160, v152
    v_xor_b32 v159, 192, v152
    v_xor_b32 v3, 224, v152
    s_lshl_b32 s56, s15, 6
    v_bfe_u32 v114, v0, 2, 2
    v_lshrrev_b32 v115, 5, v0
    v_lshl_add_u32 v114, v115, 3, v114
    v_lshlrev_b32 v114, 7, v114
    v_and_b32 v115, 8, v0
    v_lshl_add_u32 v114, v115, 3, v114
    v_and_b32 v115, 16, v0
    v_lshl_add_u32 v114, v115, 1, v114
    v_and_b32 v115, 1, v0
    v_lshl_add_u32 v114, v115, 4, v114
    v_and_b32 v115, 2, v0
    v_lshl_add_u32 v114, v115, 2, v114
    v_xor_b32 v114, s56, v114
    v_add_u32 v6, 65536, v114
    s_lshl_b32 s56, s14, 13
    s_lshl_b32 s57, s15, 12
    s_add_u32 s56, s56, s57
    v_lshlrev_b32 v114, 4, v0
    v_add_u32 v7, s56, v114
    s_lshl_b32 s56, s3, 2
    s_add_u32 s56, s56, 155680
    v_mov_b32 v8, 155648
    s_add_u32 s57, s3, 155648
    v_mov_b32 v9, s57
    v_mov_b32 v10, 8
    s_mov_b32 s58, 400000
    s_branch F_GPFC
F_GPF:
    s_nop 15
    s_nop 15
    s_nop 15
    s_nop 15
    s_nop 15
    s_nop 15
F_GPFC:
    ds_read_b32 v12, v8 offset:16
    s_waitcnt lgkmcnt(0)
    v_readfirstlane_b32 s57, v12
    s_sub_u32 s58, s58, 1
    s_cselect_b32 s57, 1, s57
    s_cmp_lt_u32 s57, 1
    s_cbranch_scc1 F_GPF
    ds_read_b32 v12, v8
    s_mov_b32 s58, 400000
    s_branch F_GC1
F_GS1:
    ds_read_b32 v12, v8
F_GC1:
    s_waitcnt lgkmcnt(0)
    v_readfirstlane_b32 s57, v12
    s_sub_u32 s58, s58, 1
    s_cselect_b32 s57, -1, s57
    s_andn2_b32 s57, 0x01010101, s57
    s_cbranch_scc1 F_GS1
    ds_read_b64_tr_b16 v[112:113], v6 offset:0
    ds_read_b64_tr_b16 v[114:115], v6 offset:512
    ds_read_b128 v[116:119], v152 offset:0
    ds_read_b64_tr_b16 v[120:121], v6 offset:2048
    ds_read_b64_tr_b16 v[122:123], v6 offset:2560
    ds_read_b128 v[124:127], v153 offset:0
    ds_read_b64_tr_b16 v[128:129], v6 offset:4096
    ds_read_b64_tr_b16 v[130:131], v6 offset:4608
    ds_read_b128 v[132:135], v154 offset:0
    ds_read_b64_tr_b16 v[136:137], v6 offset:6144
    ds_read_b64_tr_b16 v[138:139], v6 offset:6656
    ds_read_b128 v[140:143], v155 offset:0
    s_waitcnt lgkmcnt(9)
    v_mfma_f32_32x32x16_bf16 v[96:111], v[112:115], v[116:119], 0
    ds_read_b64_tr_b16 v[144:145], v6 offset:8192
    ds_read_b64_tr_b16 v[146:147], v6 offset:8704
    ds_read_b128 v[148:151], v157 offset:0
    s_waitcnt lgkmcnt(9)
    v_mfma_f32_32x32x16_bf16 v[96:111], v[120:123], v[124:127], v[96:111]
    ds_read_b64_tr_b16 v[112:113], v6 offset:10240
    ds_read_b64_tr_b16 v[114:115], v6 offset:10752
    ds_read_b128 v[116:119], v158 offset:0
    ds_read_b32 v12, v8
    s_waitcnt lgkmcnt(10)
    v_mfma_f32_32x32x16_bf16 v[96:111], v[128:131], v[132:135], v[96:111]
    ds_read_b64_tr_b16 v[120:121], v6 offset:12288
    ds_read_b64_tr_b16 v[122:123], v6 offset:12800
    ds_read_b128 v[124:127], v159 offset:0
    s_waitcnt lgkmcnt(10)
    v_mfma_f32_32x32x16_bf16 v[96:111], v[136:139], v[140:143], v[96:111]
    ds_read_b64_tr_b16 v[128:129], v6 offset:14336
    ds_read_b64_tr_b16 v[130:131], v6 offset:14848
    ds_read_b128 v[132:135], v3 offset:0
    s_waitcnt lgkmcnt(10)
    v_mfma_f32_32x32x16_bf16 v[96:111], v[144:147], v[148:151], v[96:111]
    s_waitcnt lgkmcnt(6)
    v_readfirstlane_b32 s57, v12
    s_andn2_b32 s57, 0x02020202, s57
    s_cbranch_scc1 F_GS2
F_GC2:
    ds_read_b64_tr_b16 v[136:137], v6 offset:16384
    ds_read_b64_tr_b16 v[138:139], v6 offset:16896
    ds_read_b128 v[140:143], v152 offset:16384
    v_mfma_f32_32x32x16_bf16 v[96:111], v[112:115], v[116:119], v[96:111]
    ds_read_b64_tr_b16 v[144:145], v6 offset:18432
    ds_read_b64_tr_b16 v[146:147], v6 offset:18944
    ds_read_b128 v[148:151], v153 offset:16384
    s_waitcnt lgkmcnt(9)
    v_mfma_f32_32x32x16_bf16 v[96:111], v[120:123], v[124:127], v[96:111]
    ds_read_b64_tr_b16 v[112:113], v6 offset:20480
    ds_read_b64_tr_b16 v[114:115], v6 offset:20992
    ds_read_b128 v[116:119], v154 offset:16384
    s_waitcnt lgkmcnt(9)
    v_mfma_f32_32x32x16_bf16 v[96:111], v[128:131], v[132:135], v[96:111]
TCH_5:
ST0_6:
    s_cbranch_execz F_DISP
    ds_read_b64_tr_b16 v[120:121], v6 offset:22528
    ds_read_b64_tr_b16 v[122:123], v6 offset:23040
    ds_read_b128 v[124:127], v155 offset:16384
    s_waitcnt lgkmcnt(9)
    v_mfma_f32_32x32x16_bf16 v[96:111], v[136:139], v[140:143], v[96:111]
    ds_write_b8 v9, v10
    ds_read_b64_tr_b16 v[128:129], v6 offset:24576
    ds_read_b64_tr_b16 v[130:131], v6 offset:25088
    ds_read_b128 v[132:135], v157 offset:16384
    s_waitcnt lgkmcnt(10)
    v_mfma_f32_32x32x16_bf16 v[96:111], v[144:147], v[148:151], v[96:111]
    ds_read_b64_tr_b16 v[136:137], v6 offset:26624
    ds_read_b64_tr_b16 v[138:139], v6 offset:27136
    ds_read_b128 v[140:143], v158 offset:16384
    ds_read_b32 v12, v8
    s_waitcnt lgkmcnt(11)
    v_mfma_f32_32x32x16_bf16 v[96:111], v[112:115], v[116:119], v[96:111]
    ds_read_b64_tr_b16 v[144:145], v6 offset:28672
    ds_read_b64_tr_b16 v[146:147], v6 offset:29184
    ds_read_b128 v[148:151], v159 offset:16384
    s_waitcnt lgkmcnt(11)
    v_mfma_f32_32x32x16_bf16 v[96:111], v[120:123], v[124:127], v[96:111]
    ds_read_b64_tr_b16 v[112:113], v6 offset:30720
    ds_read_b64_tr_b16 v[114:115], v6 offset:31232
    ds_read_b128 v[116:119], v3 offset:16384
    s_waitcnt lgkmcnt(10)
    v_mfma_f32_32x32x16_bf16 v[96:111], v[128:131], v[132:135], v[96:111]
    s_waitcnt lgkmcnt(6)
    v_readfirstlane_b32 s57, v12
    s_andn2_b32 s57, 0x04040404, s57
    s_cbranch_scc1 F_GS3
F_GC3:
    ds_read_b64_tr_b16 v[120:121], v6 offset:32768
    ds_read_b64_tr_b16 v[122:123], v6 offset:33280
    ds_read_b128 v[124:127], v152 offset:32768
    v_mfma_f32_32x32x16_bf16 v[96:111], v[136:139], v[140:143], v[96:111]
    ds_read_b64_tr_b16 v[128:129], v6 offset:34816
    ds_read_b64_tr_b16 v[130:131], v6 offset:35328
    ds_read_b128 v[132:135], v153 offset:32768
    s_waitcnt lgkmcnt(9)
    v_mfma_f32_32x32x16_bf16 v[96:111], v[144:147], v[148:151], v[96:111]
    ds_read_b64_tr_b16 v[136:137], v6 offset:36864
    ds_read_b64_tr_b16 v[138:139], v6 offset:37376
    ds_read_b128 v[140:143], v154 offset:32768
    s_waitcnt lgkmcnt(9)
    v_mfma_f32_32x32x16_bf16 v[96:111], v[112:115], v[116:119], v[96:111]
    ds_read_b64_tr_b16 v[144:145], v6 offset:38912
    ds_read_b64_tr_b16 v[146:147], v6 offset:39424
    ds_read_b128 v[148:151], v155 offset:32768
    s_waitcnt lgkmcnt(9)
    v_mfma_f32_32x32x16_bf16 v[96:111], v[120:123], v[124:127], v[96:111]
    ds_read_b64_tr_b16 v[112:113], v6 offset:40960
    ds_read_b64_tr_b16 v[114:115], v6 offset:41472
    ds_read_b128 v[116:119], v157 offset:32768
    s_waitcnt lgkmcnt(9)
    v_mfma_f32_32x32x16_bf16 v[96:111], v[128:131], v[132:135], v[96:111]
    ds_read_b64_tr_b16 v[120:121], v6 offset:43008
    ds_read_b64_tr_b16 v[122:123], v6 offset:43520
    ds_read_b128 v[124:127], v158 offset:32768
    ds_read_b64 v[12:13], v8
    s_waitcnt lgkmcnt(10)
    v_mfma_f32_32x32x16_bf16 v[96:111], v[136:139], v[140:143], v[96:111]
    ds_read_b64_tr_b16 v[128:129], v6 offset:45056
    ds_read_b64_tr_b16 v[130:131], v6 offset:45568
    ds_read_b128 v[132:135], v159 offset:32768
    s_waitcnt lgkmcnt(10)
    v_mfma_f32_32x32x16_bf16 v[96:111], v[144:147], v[148:151], v[96:111]
    ds_read_b64_tr_b16 v[136:137], v6 offset:47104
    ds_read_b64_tr_b16 v[138:139], v6 offset:47616
    ds_read_b128 v[140:143], v3 offset:32768
    s_waitcnt lgkmcnt(10)
    v_mfma_f32_32x32x16_bf16 v[96:111], v[112:115], v[116:119], v[96:111]
    s_waitcnt lgkmcnt(6)
    v_and_b32 v12, v12, v13
    s_nop 0
    v_readfirstlane_b32 s57, v12
    s_andn2_b32 s57, 0x08080808, s57
    s_cbranch_scc1 F_GS4
F_GC4:
    ds_read_b64_tr_b16 v[144:145], v6 offset:49152
    ds_read_b64_tr_b16 v[146:147], v6 offset:49664
    ds_read_b128 v[148:151], v152 offset:49152
    v_mfma_f32_32x32x16_bf16 v[96:111], v[120:123], v[124:127], v[96:111]
    ds_read_b64_tr_b16 v[112:113], v6 offset:51200
    ds_read_b64_tr_b16 v[114:115], v6 offset:51712
    ds_read_b128 v[116:119], v153 offset:49152
    s_waitcnt lgkmcnt(9)
    v_mfma_f32_32x32x16_bf16 v[96:111], v[128:131], v[132:135], v[96:111]
    ds_read_b64_tr_b16 v[120:121], v6 offset:53248
    ds_read_b64_tr_b16 v[122:123], v6 offset:53760
    ds_read_b128 v[124:127], v154 offset:49152
    s_waitcnt lgkmcnt(9)
    v_mfma_f32_32x32x16_bf16 v[96:111], v[136:139], v[140:143], v[96:111]
    ds_read_b64_tr_b16 v[128:129], v6 offset:55296
    ds_read_b64_tr_b16 v[130:131], v6 offset:55808
    ds_read_b128 v[132:135], v155 offset:49152
    s_waitcnt lgkmcnt(9)
    v_mfma_f32_32x32x16_bf16 v[96:111], v[144:147], v[148:151], v[96:111]
    ds_read_b64_tr_b16 v[136:137], v6 offset:57344
    ds_read_b64_tr_b16 v[138:139], v6 offset:57856
    ds_read_b128 v[140:143], v157 offset:49152
    s_waitcnt lgkmcnt(9)
    v_mfma_f32_32x32x16_bf16 v[96:111], v[112:115], v[116:119], v[96:111]
    ds_read_b64_tr_b16 v[144:145], v6 offset:59392
    ds_read_b64_tr_b16 v[146:147], v6 offset:59904
    ds_read_b128 v[148:151], v158 offset:49152
    s_waitcnt lgkmcnt(9)
    v_mfma_f32_32x32x16_bf16 v[96:111], v[120:123], v[124:127], v[96:111]
    ds_read_b64_tr_b16 v[112:113], v6 offset:61440
    ds_read_b64_tr_b16 v[114:115], v6 offset:61952
    ds_read_b128 v[116:119], v159 offset:49152
    s_waitcnt lgkmcnt(9)
    v_mfma_f32_32x32x16_bf16 v[96:111], v[128:131], v[132:135], v[96:111]
    ds_read_b64_tr_b16 v[120:121], v6 offset:63488
    ds_read_b64_tr_b16 v[122:123], v6 offset:64000
    ds_read_b128 v[124:127], v3 offset:49152
    s_waitcnt lgkmcnt(9)
    v_mfma_f32_32x32x16_bf16 v[96:111], v[136:139], v[140:143], v[96:111]
    s_waitcnt lgkmcnt(6)
    v_mfma_f32_32x32x16_bf16 v[96:111], v[144:147], v[148:151], v[96:111]
    v_mov_b32 v8, 0
    v_mov_b32 v9, 0
    v_mov_b32 v10, 0
    v_mov_b32 v11, 0
    s_waitcnt lgkmcnt(3)
    v_mfma_f32_32x32x16_bf16 v[96:111], v[112:115], v[116:119], v[96:111]
    v_mov_b32 v12, 0
    v_mov_b32 v13, 0
    v_mov_b32 v14, 0
    v_mov_b32 v15, 0
    s_waitcnt lgkmcnt(0)
    v_mfma_f32_32x32x16_bf16 v[96:111], v[120:123], v[124:127], v[96:111]
    v_mov_b32 v16, 0
    v_mov_b32 v17, 0
    v_mov_b32 v18, 0
    v_mov_b32 v19, 0
    s_nop 7
    v_cvt_pk_bf16_f32 v112, v96, v97
    v_cvt_pk_bf16_f32 v113, v98, v99
    v_cvt_pk_bf16_f32 v114, v100, v101
    v_cvt_pk_bf16_f32 v115, v102, v103
    v_cvt_pk_bf16_f32 v116, v104, v105
    v_cvt_pk_bf16_f32 v117, v106, v107
    v_cvt_pk_bf16_f32 v118, v108, v109
    v_cvt_pk_bf16_f32 v119, v110, v111
    ds_write_b128 v7, v[112:115]
    ds_write_b128 v7, v[116:119] offset:2048
    s_sub_u32 s56, s56, 32
    v_mov_b32 v157, s56
TCH_6:
ST0_7:
    s_cbranch_execz F_DISP
    ds_write_b32 v157, v157 offset:48
    ds_read_b32 v142, v157 offset:64
F_BQ:
    s_and_b32 s10, s3, 4
    s_add_u32 s11, s10, 155712
    v_mov_b32 v3, s11
    s_mov_b32 s58, 400000
    ds_read2_b32 v[140:141], v3 offset1:2
    ds_read_b128 v[96:99], v4
    ds_read_b128 v[108:111], v160
    ds_read_b128 v[112:115], v161
    ds_read_b128 v[116:119], v162
    ds_read_b128 v[120:123], v163
    s_mov_b64 exec, s[68:69]
    ds_read_b128 v[72:75], v5 offset:1024
    ds_read_b128 v[76:79], v5 offset:1536
    buffer_load_dwordx4 v[80:83], v2, s[44:47], s66 offen offset:3072 sc1
    buffer_load_dwordx4 v[84:87], v2, s[44:47], s66 offen offset:3584 sc1
    s_mov_b64 exec, -1
    buffer_load_dwordx4 v[100:103], v1, s[44:47], s66 offen offset:2048 sc1
    s_add_u32 s66, s66, 4096
    buffer_load_dwordx4 v[104:107], v1, s[44:47], s66 offen sc1
    s_lshl_b32 s11, s10, 2
    s_add_u32 s11, s11, 155744
    v_mov_b32 v159, s11
    v_mov_b32 v158, 2
    s_branch F_QC
F_QS0:
    v_readfirstlane_b32 s57, v142
    s_cmp_eq_u32 s57, 0
    s_cbranch_scc1 F_GKS
F_QS:
    ds_read2_b32 v[140:141], v3 offset1:2
    s_waitcnt lgkmcnt(0)
    v_min_u32 v140, v140, v141
    s_nop 0
    v_readfirstlane_b32 s57, v140
    s_sub_u32 s58, s58, 1
    s_cselect_b32 s58, 0, s58
    s_cselect_b32 s57, 1, s57
    s_cmp_eq_u32 s57, 0
    s_cbranch_scc1 F_QS
    ds_read_b128 v[108:111], v160
    ds_read_b128 v[112:115], v161
    ds_read_b128 v[116:119], v162
    ds_read_b128 v[120:123], v163
F_QC:
    s_waitcnt lgkmcnt(0)
    v_mfma_f32_32x32x16_bf16 v[124:139], v[96:99], v[108:111], 0
    v_min3_u32 v140, v140, v141, v142
    s_nop 0
    v_readfirstlane_b32 s57, v140
    s_sub_u32 s58, s58, 1
    s_cselect_b32 s57, 1, s57
    s_cmp_eq_u32 s57, 0
    s_cbranch_scc1 F_QS0
    ds_write_b32 v157, v158 offset:96
    v_mov_b32 v3, 155648
    s_setprio 0
    s_cmp_lt_u32 s3, 4
    s_cbranch_scc1 F_PR1
    s_setprio 1
F_PR1:
    s_mov_b32 s67, 5
    s_cselect_b32 s65, 64, 2
    v_exp_f32 v124, v124
    v_exp_f32 v125, v125
    s_branch F_ENTER
F_LOOP:
    v_exp_f32 v124, v124
    v_exp_f32 v125, v125
    v_smfmac_f32_32x32x32_bf16 v[24:39], v[92:95], v[148:155], v156
    v_exp_f32 v126, v126
    v_exp_f32 v127, v127
    v_exp_f32 v128, v128
    v_mfma_f32_32x32x16_bf16 v[140:155], v[104:107], v[120:123], 0
    buffer_load_dwordx4 v[104:107], v1, s[44:47], s66 offen sc1
    v_exp_f32 v129, v129
    v_exp_f32 v130, v130
    v_exp_f32 v131, v131
    v_exp_f32 v132, v132
    v_exp_f32 v133, v133
    v_exp_f32 v134, v134
    v_smfmac_f32_32x32x32_bf16 v[40:55], v[88:91], v[124:131], v156
    v_exp_f32 v135, v135
    v_exp_f32 v136, v136
    v_exp_f32 v137, v137
    v_exp_f32 v138, v138
    v_exp_f32 v139, v139
    v_exp_f32 v140, v140
    v_exp_f32 v141, v141
    v_smfmac_f32_32x32x32_bf16 v[40:55], v[92:95], v[132:139], v156
    s_waitcnt vmcnt(4)
    v_exp_f32 v142, v142
    v_exp_f32 v143, v143
    v_exp_f32 v144, v144
    v_mfma_f32_32x32x16_bf16 v[124:139], v[96:99], v[108:111], 0
    v_exp_f32 v145, v145
    v_exp_f32 v146, v146
    v_exp_f32 v147, v147
    v_exp_f32 v148, v148
    v_exp_f32 v149, v149
    v_exp_f32 v150, v150
    v_smfmac_f32_32x32x32_bf16 v[56:71], v[88:91], v[140:147], v156
    v_exp_f32 v151, v151
    v_exp_f32 v152, v152
    v_exp_f32 v153, v153
    v_exp_f32 v154, v154
    v_exp_f32 v155, v155
    v_exp_f32 v124, v124
    v_exp_f32 v125, v125
    v_smfmac_f32_32x32x32_bf16 v[56:71], v[92:95], v[148:155], v156
F_ENTER:
    s_mov_b64 exec, s[68:69]
    buffer_load_dwordx4 v[88:91], v2, s[44:47], s66 offen offset:1024 sc1
    buffer_load_dwordx4 v[92:95], v2, s[44:47], s66 offen offset:1536 sc1
    s_mov_b64 exec, -1
    v_exp_f32 v126, v126
    v_exp_f32 v127, v127
    v_exp_f32 v128, v128
    v_mfma_f32_32x32x16_bf16 v[140:155], v[96:99], v[112:115], 0
    v_exp_f32 v129, v129
    v_exp_f32 v130, v130
    v_exp_f32 v131, v131
    v_exp_f32 v132, v132
    v_exp_f32 v133, v133
    v_exp_f32 v134, v134
    v_smfmac_f32_32x32x32_bf16 v[8:23], v[72:75], v[124:131], v156
    v_exp_f32 v135, v135
    v_exp_f32 v136, v136
    v_exp_f32 v137, v137
    v_exp_f32 v138, v138
    v_exp_f32 v139, v139
    v_exp_f32 v140, v140
    v_exp_f32 v141, v141
    v_smfmac_f32_32x32x32_bf16 v[8:23], v[76:79], v[132:139], v156
    s_add_u32 s66, s66, 2048
    s_and_b32 s66, s66, 0x7fff
    v_exp_f32 v142, v142
    v_exp_f32 v143, v143
    v_exp_f32 v144, v144
    v_mfma_f32_32x32x16_bf16 v[124:139], v[96:99], v[116:119], 0
    s_cmp_eq_u32 s67, s65
    s_cbranch_scc0 F_PRI
    s_setprio 0
F_PRI:
    v_exp_f32 v145, v145
    v_exp_f32 v146, v146
    v_exp_f32 v147, v147
    v_exp_f32 v148, v148
    v_exp_f32 v149, v149
    v_exp_f32 v150, v150
    v_smfmac_f32_32x32x32_bf16 v[24:39], v[72:75], v[140:147], v156
    v_exp_f32 v151, v151
    v_exp_f32 v152, v152
    v_exp_f32 v153, v153
    v_exp_f32 v154, v154
    v_exp_f32 v155, v155
    v_exp_f32 v124, v124
    v_exp_f32 v125, v125
    v_smfmac_f32_32x32x32_bf16 v[24:39], v[76:79], v[148:155], v156
    v_exp_f32 v126, v126
    v_exp_f32 v127, v127
    v_exp_f32 v128, v128
    v_mfma_f32_32x32x16_bf16 v[140:155], v[96:99], v[120:123], 0
    buffer_load_dwordx4 v[96:99], v1, s[44:47], s66 offen sc1
    v_exp_f32 v129, v129
    v_exp_f32 v130, v130
    v_exp_f32 v131, v131
    v_exp_f32 v132, v132
    v_exp_f32 v133, v133
    v_exp_f32 v134, v134
    v_smfmac_f32_32x32x32_bf16 v[40:55], v[72:75], v[124:131], v156
    v_exp_f32 v135, v135
    v_exp_f32 v136, v136
    v_exp_f32 v137, v137
    v_exp_f32 v138, v138
    v_exp_f32 v139, v139
    v_exp_f32 v140, v140
    v_exp_f32 v141, v141
    v_smfmac_f32_32x32x32_bf16 v[40:55], v[76:79], v[132:139], v156
    s_waitcnt vmcnt(4)
    v_exp_f32 v142, v142
    v_exp_f32 v143, v143
    v_exp_f32 v144, v144
    v_mfma_f32_32x32x16_bf16 v[124:139], v[100:103], v[108:111], 0
    v_exp_f32 v145, v145
    v_exp_f32 v146, v146
    v_exp_f32 v147, v147
    v_exp_f32 v148, v148
    v_exp_f32 v149, v149
    v_exp_f32 v150, v150
    v_smfmac_f32_32x32x32_bf16 v[56:71], v[72:75], v[140:147], v156
    v_exp_f32 v151, v151
    v_exp_f32 v152, v152
    v_exp_f32 v153, v153
    v_exp_f32 v154, v154
    v_exp_f32 v155, v155
    v_exp_f32 v124, v124
    v_exp_f32 v125, v125
    v_smfmac_f32_32x32x32_bf16 v[56:71], v[76:79], v[148:155], v156
    s_mov_b64 exec, s[68:69]
    buffer_load_dwordx4 v[72:75], v2, s[44:47], s66 offen offset:1024 sc1
    buffer_load_dwordx4 v[76:79], v2, s[44:47], s66 offen offset:1536 sc1
    s_mov_b64 exec, -1
    v_exp_f32 v126, v126
    v_exp_f32 v127, v127
    v_exp_f32 v128, v128
    v_mfma_f32_32x32x16_bf16 v[140:155], v[100:103], v[112:115], 0
TCH_7:
ST0_8:
    s_cbranch_execz F_DISP
    v_exp_f32 v129, v129
    v_exp_f32 v130, v130
    v_exp_f32 v131, v131
    v_exp_f32 v132, v132
    v_exp_f32 v133, v133
    v_exp_f32 v134, v134
    v_smfmac_f32_32x32x32_bf16 v[8:23], v[80:83], v[124:131], v156
    v_exp_f32 v135, v135
    v_exp_f32 v136, v136
    v_exp_f32 v137, v137
    v_exp_f32 v138, v138
    v_exp_f32 v139, v139
    v_exp_f32 v140, v140
    v_exp_f32 v141, v141
    v_smfmac_f32_32x32x32_bf16 v[8:23], v[84:87], v[132:139], v156
    s_add_u32 s66, s66, 2048
    s_and_b32 s66, s66, 0x7fff
    v_exp_f32 v142, v142
    v_exp_f32 v143, v143
    v_exp_f32 v144, v144
    v_mfma_f32_32x32x16_bf16 v[124:139], v[100:103], v[116:119], 0
    v_exp_f32 v145, v145
    v_exp_f32 v146, v146
    v_exp_f32 v147, v147
    v_exp_f32 v148, v148
    v_exp_f32 v149, v149
    v_exp_f32 v150, v150
    v_smfmac_f32_32x32x32_bf16 v[24:39], v[80:83], v[140:147], v156
    v_exp_f32 v151, v151
    v_exp_f32 v152, v152
    v_exp_f32 v153, v153
    v_exp_f32 v154, v154
    v_exp_f32 v155, v155
    v_exp_f32 v124, v124
    v_exp_f32 v125, v125
    v_smfmac_f32_32x32x32_bf16 v[24:39], v[84:87], v[148:155], v156
    v_exp_f32 v126, v126
    v_exp_f32 v127, v127
    v_exp_f32 v128, v128
    v_mfma_f32_32x32x16_bf16 v[140:155], v[100:103], v[120:123], 0
    buffer_load_dwordx4 v[100:103], v1, s[44:47], s66 offen sc1
    v_exp_f32 v129, v129
    v_exp_f32 v130, v130
    v_exp_f32 v131, v131
    v_exp_f32 v132, v132
    v_exp_f32 v133, v133
    v_exp_f32 v134, v134
    v_smfmac_f32_32x32x32_bf16 v[40:55], v[80:83], v[124:131], v156
    v_exp_f32 v135, v135
    v_exp_f32 v136, v136
    v_exp_f32 v137, v137
    v_exp_f32 v138, v138
    v_exp_f32 v139, v139
    v_exp_f32 v140, v140
    v_exp_f32 v141, v141
    v_smfmac_f32_32x32x32_bf16 v[40:55], v[84:87], v[132:139], v156
    s_waitcnt vmcnt(4)
    v_exp_f32 v142, v142
    v_exp_f32 v143, v143
    v_exp_f32 v144, v144
    v_mfma_f32_32x32x16_bf16 v[124:139], v[104:107], v[108:111], 0
    v_exp_f32 v145, v145
    v_exp_f32 v146, v146
    v_exp_f32 v147, v147
    v_exp_f32 v148, v148
    v_exp_f32 v149, v149
    v_exp_f32 v150, v150
    v_smfmac_f32_32x32x32_bf16 v[56:71], v[80:83], v[140:147], v156
    v_exp_f32 v151, v151
    v_exp_f32 v152, v152
    v_exp_f32 v153, v153
    v_exp_f32 v154, v154
    v_exp_f32 v155, v155
    v_exp_f32 v124, v124
    v_exp_f32 v125, v125
    v_smfmac_f32_32x32x32_bf16 v[56:71], v[84:87], v[148:155], v156
    s_mov_b64 exec, s[68:69]
    buffer_load_dwordx4 v[80:83], v2, s[44:47], s66 offen offset:1024 sc1
    buffer_load_dwordx4 v[84:87], v2, s[44:47], s66 offen offset:1536 sc1
    s_mov_b64 exec, -1
    v_exp_f32 v126, v126
    v_exp_f32 v127, v127
    v_exp_f32 v128, v128
    v_mfma_f32_32x32x16_bf16 v[140:155], v[104:107], v[112:115], 0
    v_exp_f32 v129, v129
    v_exp_f32 v130, v130
    v_exp_f32 v131, v131
    v_exp_f32 v132, v132
    v_exp_f32 v133, v133
    v_exp_f32 v134, v134
    v_smfmac_f32_32x32x32_bf16 v[8:23], v[88:91], v[124:131], v156
    v_exp_f32 v135, v135
    v_exp_f32 v136, v136
    v_exp_f32 v137, v137
    v_exp_f32 v138, v138
    v_exp_f32 v139, v139
    v_exp_f32 v140, v140
    v_exp_f32 v141, v141
    v_smfmac_f32_32x32x32_bf16 v[8:23], v[92:95], v[132:139], v156
    s_add_u32 s66, s66, 2048
    s_and_b32 s66, s66, 0x7fff
    v_exp_f32 v142, v142
    v_exp_f32 v143, v143
    v_exp_f32 v144, v144
    v_mfma_f32_32x32x16_bf16 v[124:139], v[104:107], v[116:119], 0
    v_exp_f32 v145, v145
    v_exp_f32 v146, v146
    v_exp_f32 v147, v147
    v_exp_f32 v148, v148
    v_exp_f32 v149, v149
    v_exp_f32 v150, v150
    v_smfmac_f32_32x32x32_bf16 v[24:39], v[88:91], v[140:147], v156
    s_sub_u32 s67, s67, 1
    s_cmp_lg_u32 s67, 0
    v_exp_f32 v151, v151
    v_exp_f32 v152, v152
    v_exp_f32 v153, v153
    v_exp_f32 v154, v154
    v_exp_f32 v155, v155
    s_cbranch_scc1 F_LOOP
    v_exp_f32 v124, v124
    v_exp_f32 v125, v125
    v_smfmac_f32_32x32x32_bf16 v[24:39], v[92:95], v[148:155], v156
    s_waitcnt vmcnt(5)
    v_exp_f32 v126, v126
    s_lshr_b32 s10, s3, 2
    v_exp_f32 v127, v127
    s_lshl_b32 s11, s6, 1
    v_exp_f32 v128, v128
    s_add_u32 s11, s11, s10
    v_mfma_f32_32x32x16_bf16 v[140:155], v[96:99], v[108:111], 0
    v_exp_f32 v129, v129
    s_lshl_b32 s12, s11, 15
    v_exp_f32 v130, v130
    s_add_u32 s12, s12, 0x20000
    v_exp_f32 v131, v131
    s_mul_i32 s13, s64, 31744
    v_exp_f32 v132, v132
    s_sub_u32 s13, s12, s13
    v_exp_f32 v133, v133
    s_lshl_b32 s14, s7, 12
    v_exp_f32 v134, v134
    s_add_u32 s13, s13, s14
    v_smfmac_f32_32x32x32_bf16 v[40:55], v[88:91], v[124:131], v156
    v_exp_f32 v135, v135
    s_mul_i32 s14, s64, 24576
    v_exp_f32 v136, v136
    s_sub_u32 s14, s12, s14
    v_exp_f32 v137, v137
    v_exp_f32 v138, v138
    v_exp_f32 v139, v139
    v_exp_f32 v140, v140
    v_exp_f32 v141, v141
    v_smfmac_f32_32x32x32_bf16 v[40:55], v[92:95], v[132:139], v156
    s_waitcnt vmcnt(3)
    ds_read_b128 v[4:7], v3 offset:32
    v_exp_f32 v142, v142
    v_exp_f32 v143, v143
    s_cmp_eq_u32 s65, 2
    s_cbranch_scc0 F_PRJ
    s_setprio 2
F_PRJ:
    v_exp_f32 v144, v144
    v_mfma_f32_32x32x16_bf16 v[124:139], v[96:99], v[112:115], 0
    v_exp_f32 v145, v145
    v_exp_f32 v146, v146
    v_exp_f32 v147, v147
    v_exp_f32 v148, v148
    s_waitcnt lgkmcnt(0)
    v_min3_u32 v4, v4, v5, v6
    v_exp_f32 v149, v149
    v_min_u32 v4, v4, v7
    v_exp_f32 v150, v150
    v_readfirstlane_b32 s57, v4
    v_smfmac_f32_32x32x32_bf16 v[8:23], v[72:75], v[140:147], v156
    v_exp_f32 v151, v151
    s_cmp_lt_u32 s57, 6
    s_cbranch_scc1 F_CS
F_CSC:
    v_exp_f32 v152, v152
    v_xor_b32 v5, 12, v157
    v_exp_f32 v153, v153
    v_xor_b32 v6, 8, v157
    v_exp_f32 v154, v154
    v_xor_b32 v7, 4, v157
    v_exp_f32 v155, v155
    v_exp_f32 v124, v124
    v_exp_f32 v125, v125
    v_smfmac_f32_32x32x32_bf16 v[8:23], v[76:79], v[148:155], v156
    v_exp_f32 v126, v126
    v_exp_f32 v127, v127
    v_exp_f32 v128, v128
    v_mfma_f32_32x32x16_bf16 v[140:155], v[96:99], v[116:119], 0
    v_exp_f32 v129, v129
    v_exp_f32 v130, v130
    v_exp_f32 v131, v131
    v_exp_f32 v132, v132
    v_exp_f32 v133, v133
    v_exp_f32 v134, v134
    v_smfmac_f32_32x32x32_bf16 v[24:39], v[72:75], v[124:131], v156
    v_exp_f32 v135, v135
    ds_write_b128 v160, v[8:11] offset:0
    v_exp_f32 v136, v136
    ds_write_b128 v160, v[12:15] offset:1024
    v_exp_f32 v137, v137
    ds_write_b32 v164, v16 offset:49152
    v_exp_f32 v138, v138
    ds_write_b8 v5, v156 offset:128
    v_exp_f32 v139, v139
    v_exp_f32 v140, v140
    v_exp_f32 v141, v141
    v_smfmac_f32_32x32x32_bf16 v[24:39], v[76:79], v[132:139], v156
    v_exp_f32 v142, v142
    v_exp_f32 v143, v143
    v_exp_f32 v144, v144
    v_mfma_f32_32x32x16_bf16 v[124:139], v[104:107], v[120:123], 0
TCH_8:
ST0_9:
    s_cbranch_execz F_S0
    v_exp_f32 v145, v145
    v_exp_f32 v146, v146
    v_exp_f32 v147, v147
    v_exp_f32 v148, v148
    v_exp_f32 v149, v149
    v_exp_f32 v150, v150
    v_smfmac_f32_32x32x32_bf16 v[40:55], v[72:75], v[140:147], v156
    v_exp_f32 v151, v151
    ds_write_b128 v161, v[24:27] offset:16384
    v_exp_f32 v152, v152
    ds_write_b128 v161, v[28:31] offset:17408
    v_exp_f32 v153, v153
    ds_write_b32 v165, v32 offset:53248
    v_exp_f32 v154, v154
    ds_write_b8 v6, v156 offset:129
    v_exp_f32 v155, v155
    v_exp_f32 v124, v124
    v_exp_f32 v125, v125
    v_smfmac_f32_32x32x32_bf16 v[40:55], v[76:79], v[148:155], v156
    v_exp_f32 v126, v126
    v_exp_f32 v127, v127
    v_exp_f32 v128, v128
    v_mfma_f32_32x32x16_bf16 v[140:155], v[96:99], v[120:123], 0
    v_exp_f32 v129, v129
    v_exp_f32 v130, v130
    v_exp_f32 v131, v131
    v_exp_f32 v132, v132
    v_exp_f32 v133, v133
    v_exp_f32 v134, v134
    v_smfmac_f32_32x32x32_bf16 v[56:71], v[88:91], v[124:131], v156
    s_nop 0
    ds_write_b128 v162, v[40:43] offset:32768
    v_exp_f32 v135, v135
    ds_write_b128 v162, v[44:47] offset:33792
    ds_write_b32 v166, v48 offset:57344
    ds_write_b8 v7, v156 offset:130
    v_exp_f32 v136, v136
    v_exp_f32 v137, v137
    ds_read_b32 v4, v157 offset:128
    v_exp_f32 v138, v138
    ds_read_b32 v16, v167 offset:49152
    v_exp_f32 v139, v139
    ds_read_b128 v[8:11], v163 offset:0
    v_exp_f32 v140, v140
    ds_read_b128 v[12:15], v163 offset:1024
    v_exp_f32 v141, v141
    ds_read_b32 v32, v167 offset:53248
    v_smfmac_f32_32x32x32_bf16 v[56:71], v[92:95], v[132:139], v156
    v_exp_f32 v142, v142
    ds_read_b128 v[24:27], v163 offset:16384
    v_exp_f32 v143, v143
    ds_read_b128 v[28:31], v163 offset:17408
    v_exp_f32 v144, v144
    ds_read_b32 v5, v157 offset:128
    v_exp_f32 v145, v145
    ds_read_b32 v48, v167 offset:57344
    v_exp_f32 v146, v146
    ds_read_b128 v[40:43], v163 offset:32768
    v_exp_f32 v147, v147
    ds_read_b128 v[44:47], v163 offset:33792
    v_exp_f32 v148, v148
    v_smfmac_f32_32x32x32_bf16 v[56:71], v[72:75], v[140:147], v156
    v_exp_f32 v149, v149
    v_exp_f32 v150, v150
    v_exp_f32 v151, v151
    v_exp_f32 v152, v152
    v_exp_f32 v153, v153
    v_exp_f32 v154, v154
    s_waitcnt lgkmcnt(10)
    v_readfirstlane_b32 s56, v4
    v_exp_f32 v155, v155
    s_waitcnt lgkmcnt(3)
    v_readfirstlane_b32 s57, v5
    v_smfmac_f32_32x32x32_bf16 v[56:71], v[76:79], v[148:155], v156
    s_pack_lh_b32_b16 s57, s56, s57
    v_add_f32 v16, v16, v32
    s_cmp_lg_u32 s57, 0xdddddd
    v_pk_add_f32 v[8:9], v[8:9], v[24:25]
    v_pk_add_f32 v[10:11], v[10:11], v[26:27]
    v_pk_add_f32 v[12:13], v[12:13], v[28:29]
    v_pk_add_f32 v[14:15], v[14:15], v[30:31]
    s_cbranch_scc1 F_RS
F_RSC:
    s_waitcnt vmcnt(0) lgkmcnt(0)
    v_add_f32 v16, v16, v48
    v_pk_add_f32 v[8:9], v[8:9], v[40:41]
    v_pk_add_f32 v[10:11], v[10:11], v[42:43]
    v_pk_add_f32 v[12:13], v[12:13], v[44:45]
    v_pk_add_f32 v[14:15], v[14:15], v[46:47]
    v_add_f32 v64, v64, v16
    v_rcp_f32 v65, v64
    v_pk_add_f32 v[56:57], v[56:57], v[8:9]
    v_pk_add_f32 v[58:59], v[58:59], v[10:11]
    v_pk_add_f32 v[60:61], v[60:61], v[12:13]
    v_pk_add_f32 v[62:63], v[62:63], v[14:15]
    v_max_f32 v66, v64, v65
    v_pk_add_f32 v[8:9], v[56:57], v[58:59]
    v_pk_add_f32 v[10:11], v[60:61], v[62:63]
    v_pk_mul_f32 v[56:57], v[56:57], v[64:65] op_sel:[0,1] op_sel_hi:[1,1]
    v_pk_add_f32 v[8:9], v[8:9], v[10:11]
    v_pk_mul_f32 v[58:59], v[58:59], v[64:65] op_sel:[0,1] op_sel_hi:[1,1]
    v_fma_f32 v66, v8, 0, v66
    v_pk_mul_f32 v[60:61], v[60:61], v[64:65] op_sel:[0,1] op_sel_hi:[1,1]
    v_fma_f32 v66, v9, 0, v66
    v_pk_mul_f32 v[62:63], v[62:63], v[64:65] op_sel:[0,1] op_sel_hi:[1,1]
    v_cmp_nge_f32 vcc, 0x5f800000, v66
    v_cvt_pk_bf16_f32 v56, v56, v57
    v_cvt_pk_bf16_f32 v57, v58, v59
    v_cvt_pk_bf16_f32 v58, v60, v61
    v_cvt_pk_bf16_f32 v59, v62, v63
    s_cbranch_vccnz F_SLOW
F_NORM:
    buffer_store_dwordx4 v[56:59], v1, s[44:47], s13 offen
    s_add_u32 s59, s13, 0x200000
    v_mov_b32 v158, 4
    ds_write_b32 v157, v158 offset:96
    s_cmp_lt_u32 s3, 4
    s_cbranch_scc0 F_FIN
    s_xor_b32 s56, s64, 3
    s_lshl_b32 s56, s56, 5
    s_lshl_b32 s57, s64, 14
    s_add_u32 s57, s57, 65536
    v_bfe_u32 v4, v0, 2, 2
    v_lshrrev_b32 v5, 5, v0
    v_lshl_add_u32 v4, v5, 3, v4
    v_lshlrev_b32 v4, 7, v4
    v_and_b32 v5, 8, v0
    v_lshl_add_u32 v4, v5, 3, v4
    v_and_b32 v5, 16, v0
    v_lshl_add_u32 v4, v5, 1, v4
    v_and_b32 v5, 1, v0
    v_lshl_add_u32 v4, v5, 4, v4
    v_and_b32 v5, 2, v0
    v_lshl_add_u32 v4, v5, 2, v4
    v_xor_b32 v4, s56, v4
    v_add_u32 v153, s57, v4
    v_xor_b32 v154, 64, v153
    ds_read_b64_tr_b16 v[72:73], v153 offset:0
    ds_read_b64_tr_b16 v[74:75], v153 offset:512
    ds_read_b64_tr_b16 v[76:77], v153 offset:2048
    ds_read_b64_tr_b16 v[78:79], v153 offset:2560
    ds_read_b64_tr_b16 v[80:81], v153 offset:4096
    ds_read_b64_tr_b16 v[82:83], v153 offset:4608
    ds_read_b64_tr_b16 v[84:85], v153 offset:6144
    ds_read_b64_tr_b16 v[86:87], v153 offset:6656
    ds_read_b64_tr_b16 v[88:89], v153 offset:8192
    ds_read_b64_tr_b16 v[90:91], v153 offset:8704
    ds_read_b64_tr_b16 v[92:93], v153 offset:10240
    ds_read_b64_tr_b16 v[94:95], v153 offset:10752
    ds_read_b64_tr_b16 v[96:97], v153 offset:12288
    ds_read_b64_tr_b16 v[98:99], v153 offset:12800
    ds_read_b64_tr_b16 v[100:101], v153 offset:14336
    ds_read_b64_tr_b16 v[102:103], v153 offset:14848
    ds_read_b64_tr_b16 v[104:105], v154 offset:0
    ds_read_b64_tr_b16 v[106:107], v154 offset:512
    ds_read_b64_tr_b16 v[108:109], v154 offset:2048
    ds_read_b64_tr_b16 v[110:111], v154 offset:2560
    ds_read_b64_tr_b16 v[112:113], v154 offset:4096
    ds_read_b64_tr_b16 v[114:115], v154 offset:4608
    ds_read_b64_tr_b16 v[116:117], v154 offset:6144
    ds_read_b64_tr_b16 v[118:119], v154 offset:6656
    ds_read_b64_tr_b16 v[120:121], v154 offset:8192
    ds_read_b64_tr_b16 v[122:123], v154 offset:8704
    ds_read_b64_tr_b16 v[124:125], v154 offset:10240
ST0_10:
    s_cbranch_execz F_HT
    ds_read_b64_tr_b16 v[126:127], v154 offset:10752
    ds_read_b64_tr_b16 v[128:129], v154 offset:12288
    ds_read_b64_tr_b16 v[130:131], v154 offset:12800
    ds_read_b64_tr_b16 v[132:133], v154 offset:14336
    ds_read_b64_tr_b16 v[134:135], v154 offset:14848
    v_and_b32 v155, 31, v0
    v_lshlrev_b32 v155, 11, v155
    v_lshrrev_b32 v4, 5, v0
    v_lshl_add_u32 v155, v4, 4, v155
    s_lshl_b32 s11, s11, 16
    s_lshl_b32 s12, s7, 7
    s_add_u32 s11, s11, s12
    s_lshl_b32 s12, s64, 5
    s_add_u32 s11, s11, s12
    s_mov_b64 s[52:53], s[40:41]
    s_mov_b32 s54, 0x400000
    s_mov_b32 s55, 0x00020000
    s_mov_b32 s65, 4
    v_xor_b32 v60, 12, v157
    v_xor_b32 v61, 8, v157
    v_xor_b32 v62, 4, v157
    v_xor_b32 v63, 0, v157
    v_and_b32 v2, 7, v0
    v_lshlrev_b32 v2, 10, v2
    v_and_b32 v4, 8, v0
    v_lshl_add_u32 v2, v4, 18, v2
    s_lshl_b32 s13, s64, 15
    v_add_u32 v2, s13, v2
    s_mov_b32 s13, s14
    s_mov_b32 s56, 0
    s_mov_b32 s12, 200000
    ds_read_b128 v[4:7], v159
F_SP:
    s_setprio 0
    buffer_load_dword v152, v2, s[44:47], s13 offen sc1
    s_mov_b32 s14, s13
    s_waitcnt vmcnt(0)
    v_cmp_eq_u32 vcc, -1, v152
    s_or_b32 s57, vcc_lo, s56
    s_and_b32 s57, s57, 0xff
    s_cselect_b32 s56, s56, 0xff
    s_cbranch_scc0 F_OL
    s_add_u32 s14, s13, 0x200000
    s_and_b32 s57, vcc_lo, 0xff00
    s_cbranch_scc0 F_OL
    s_cmp_eq_u32 s59, 0
    s_cbranch_scc1 F_B1
    buffer_store_dwordx4 v[56:59], v1, s[44:47], s59 offen sc1
    s_mov_b32 s59, 0
F_B1:
    s_sub_u32 s12, s12, 1
    s_cbranch_scc0 F_SP
    s_mov_b32 s12, 0
F_OL:
    s_cmp_eq_u32 s65, 4
    s_cbranch_scc1 F_OL1
    s_setprio 3
F_OL1:
    s_add_u32 s15, s14, 4096
    buffer_load_dwordx4 v[8:11], v1, s[44:47], s14 offen offset:0 sc1
    buffer_load_dwordx4 v[12:15], v1, s[44:47], s14 offen offset:1024 sc1
    buffer_load_dwordx4 v[16:19], v1, s[44:47], s14 offen offset:2048 sc1
    buffer_load_dwordx4 v[20:23], v1, s[44:47], s14 offen offset:3072 sc1
    buffer_load_dwordx4 v[24:27], v1, s[44:47], s15 offen offset:0 sc1
    buffer_load_dwordx4 v[28:31], v1, s[44:47], s15 offen offset:1024 sc1
    buffer_load_dwordx4 v[32:35], v1, s[44:47], s15 offen offset:2048 sc1
    buffer_load_dwordx4 v[36:39], v1, s[44:47], s15 offen offset:3072 sc1
F_OW:
    v_mov_b32 v152, 0
    s_mov_b32 s58, 400000
    s_branch F_TSC
F_TS:
    ds_read_b128 v[4:7], v159 offset:0
F_TSC:
    s_waitcnt lgkmcnt(0)
    v_min3_u32 v4, v4, v5, v6
    v_min_u32 v4, v4, v7
    s_nop 0
    v_readfirstlane_b32 s57, v4
    s_sub_u32 s58, s58, 1
    s_cselect_b32 s57, s65, s57
    s_cmp_lt_u32 s57, s65
    s_cbranch_scc1 F_TS
    s_waitcnt vmcnt(7)
    v_mfma_f32_32x32x16_bf16 v[40:55], v[72:75], v[8:11], 0
    v_max3_u32 v152, v8, v9, v152
    v_max3_u32 v152, v10, v11, v152
    s_waitcnt vmcnt(6)
    v_mfma_f32_32x32x16_bf16 v[40:55], v[76:79], v[12:15], v[40:55]
    v_max3_u32 v152, v12, v13, v152
    v_max3_u32 v152, v14, v15, v152
    s_waitcnt vmcnt(5)
    v_mfma_f32_32x32x16_bf16 v[40:55], v[80:83], v[16:19], v[40:55]
    v_max3_u32 v152, v16, v17, v152
    v_max3_u32 v152, v18, v19, v152
    s_waitcnt vmcnt(4)
    v_mfma_f32_32x32x16_bf16 v[40:55], v[84:87], v[20:23], v[40:55]
    v_max3_u32 v152, v20, v21, v152
    v_max3_u32 v152, v22, v23, v152
    s_waitcnt vmcnt(3)
    v_mfma_f32_32x32x16_bf16 v[40:55], v[88:91], v[24:27], v[40:55]
    v_max3_u32 v152, v24, v25, v152
    v_max3_u32 v152, v26, v27, v152
    s_waitcnt vmcnt(2)
    v_mfma_f32_32x32x16_bf16 v[40:55], v[92:95], v[28:31], v[40:55]
    v_max3_u32 v152, v28, v29, v152
    v_max3_u32 v152, v30, v31, v152
    s_waitcnt vmcnt(1)
    v_mfma_f32_32x32x16_bf16 v[40:55], v[96:99], v[32:35], v[40:55]
    v_max3_u32 v152, v32, v33, v152
    v_max3_u32 v152, v34, v35, v152
    s_waitcnt vmcnt(0)
    v_mfma_f32_32x32x16_bf16 v[40:55], v[100:103], v[36:39], v[40:55]
    v_max3_u32 v152, v36, v37, v152
    v_max3_u32 v152, v38, v39, v152
    s_cmp_eq_u32 s59, 0
    s_cbranch_scc1 F_B2
    buffer_store_dwordx4 v[56:59], v1, s[44:47], s59 offen sc1
    s_mov_b32 s59, 0
F_B2:
    v_cmp_eq_u32 vcc, -1, v152
    v_mfma_f32_32x32x16_bf16 v[136:151], v[104:107], v[8:11], 0
    s_cmp_eq_u64 vcc, 0
    s_cbranch_scc1 F_OOK
    s_sub_u32 s12, s12, 1
    s_cbranch_scc0 F_SP
F_OOK:
    v_mfma_f32_32x32x16_bf16 v[136:151], v[108:111], v[12:15], v[136:151]
    s_add_u32 s65, s65, 2
    v_mov_b32 v158, s65
    v_mfma_f32_32x32x16_bf16 v[136:151], v[112:115], v[16:19], v[136:151]
    ds_write_b128 v160, v[40:43] offset:0
    v_mfma_f32_32x32x16_bf16 v[136:151], v[116:119], v[20:23], v[136:151]
    ds_write_b128 v160, v[44:47] offset:1024
    ds_write_b8 v60, v156 offset:160
    v_mfma_f32_32x32x16_bf16 v[136:151], v[120:123], v[24:27], v[136:151]
    ds_write_b128 v161, v[48:51] offset:16384
    v_mfma_f32_32x32x16_bf16 v[136:151], v[124:127], v[28:31], v[136:151]
    ds_write_b128 v161, v[52:55] offset:17408
    ds_write_b8 v61, v156 offset:161
    v_mfma_f32_32x32x16_bf16 v[136:151], v[128:131], v[32:35], v[136:151]
    v_mfma_f32_32x32x16_bf16 v[136:151], v[132:135], v[36:39], v[136:151]
    ds_read_b32 v4, v63 offset:160
    ds_read_b128 v[8:11], v163 offset:0
    ds_read_b128 v[12:15], v163 offset:1024
    ds_read_b128 v[16:19], v163 offset:16384
    ds_read_b128 v[20:23], v163 offset:17408
    s_nop 6
    ds_write_b128 v162, v[136:139] offset:32768
    ds_write_b128 v162, v[140:143] offset:33792
    ds_write_b8 v62, v156 offset:162
    ds_read_b32 v5, v63 offset:160
    ds_read_b128 v[24:27], v163 offset:32768
    ds_read_b128 v[28:31], v163 offset:33792
    s_waitcnt lgkmcnt(6)
    v_readfirstlane_b32 s57, v4
    s_andn2_b32 s57, 0xdddd, s57
    s_cbranch_scc1 F_UA
F_UAC:
    v_pk_add_f32 v[144:145], v[144:145], v[8:9]
    v_pk_add_f32 v[146:147], v[146:147], v[10:11]
    v_pk_add_f32 v[148:149], v[148:149], v[12:13]
    v_pk_add_f32 v[150:151], v[150:151], v[14:15]
    v_pk_add_f32 v[144:145], v[144:145], v[16:17]
    v_pk_add_f32 v[146:147], v[146:147], v[18:19]
    v_pk_add_f32 v[148:149], v[148:149], v[20:21]
    v_pk_add_f32 v[150:151], v[150:151], v[22:23]
    s_waitcnt lgkmcnt(2)
    v_readfirstlane_b32 s57, v5
    s_bitcmp0_b32 s57, 16
    s_cbranch_scc1 F_UB
F_UBC:
    s_waitcnt lgkmcnt(1)
    v_pk_add_f32 v[144:145], v[144:145], v[24:25]
    v_pk_add_f32 v[146:147], v[146:147], v[26:27]
    s_waitcnt lgkmcnt(0)
TCH_9:
ST0_11:
    s_cbranch_execz F_S0
    v_pk_add_f32 v[148:149], v[148:149], v[28:29]
    v_pk_add_f32 v[150:151], v[150:151], v[30:31]
    v_cvt_pk_bf16_f32 v136, v144, v145
    v_cvt_pk_bf16_f32 v137, v146, v147
    v_cvt_pk_bf16_f32 v138, v148, v149
    v_cvt_pk_bf16_f32 v139, v150, v151
    buffer_store_dwordx4 v[136:139], v155, s[52:55], s11 offen
    s_cmp_eq_u32 s65, 6
    s_cbranch_scc0 F_FIN
    ds_write_b32 v157, v158 offset:96
    s_add_u32 s13, s13, 0x8000
    s_mov_b32 s14, s13
    s_add_u32 s11, s11, 0x10000
    s_mov_b32 s56, 0
    s_mov_b32 s12, 200000
    s_setprio 0
    v_add_u32 v60, 32, v60
    v_add_u32 v61, 32, v61
    v_add_u32 v62, 32, v62
    v_add_u32 v63, 32, v63
    s_mov_b32 s58, 400000
F_P1:
    ds_read_b128 v[4:7], v159 offset:16
    s_waitcnt lgkmcnt(0)
    v_min3_u32 v4, v4, v5, v6
    v_min_u32 v4, v4, v7
    s_nop 0
    v_readfirstlane_b32 s57, v4
    s_sub_u32 s58, s58, 1
    s_cselect_b32 s57, 4, s57
    s_cmp_lt_u32 s57, 4
    s_cbranch_scc1 F_P1
    ds_read_b128 v[4:7], v159
    s_branch F_OL
F_RS:
    s_mov_b32 s58, 400000
F_RT:
    ds_read_b32 v5, v157 offset:128
    ds_read_b32 v48, v167 offset:57344
    ds_read_b128 v[40:43], v163 offset:32768
    ds_read_b128 v[44:47], v163 offset:33792
    s_sub_u32 s58, s58, 1
    s_waitcnt lgkmcnt(3)
    s_cbranch_scc1 F_RU
    v_readfirstlane_b32 s57, v5
    s_cmp_lg_u32 s57, 0xdddddd
    s_cbranch_scc1 F_RT
F_RU:
    s_andn2_b32 s57, 0xdddd, s56
    s_cbranch_scc0 F_RSC
    ds_read_b32 v16, v167 offset:49152
    ds_read_b128 v[8:11], v163 offset:0
    ds_read_b128 v[12:15], v163 offset:1024
    ds_read_b32 v32, v167 offset:53248
    ds_read_b128 v[24:27], v163 offset:16384
    ds_read_b128 v[28:31], v163 offset:17408
    s_waitcnt lgkmcnt(0)
    v_add_f32 v16, v16, v32
    v_pk_add_f32 v[8:9], v[8:9], v[24:25]
    v_pk_add_f32 v[10:11], v[10:11], v[26:27]
    v_pk_add_f32 v[12:13], v[12:13], v[28:29]
    v_pk_add_f32 v[14:15], v[14:15], v[30:31]
    s_branch F_RSC
F_CS:
    s_mov_b32 s58, 400000
F_CT:
    ds_read_b128 v[4:7], v3 offset:32
    s_sub_u32 s58, s58, 1
    s_waitcnt lgkmcnt(0)
    s_cbranch_scc1 F_CSC
    v_min3_u32 v4, v4, v5, v6
    v_min_u32 v4, v4, v7
    s_nop 0
    v_readfirstlane_b32 s57, v4
    s_cmp_lt_u32 s57, 6
    s_cbranch_scc1 F_CT
    s_branch F_CSC
F_UA:
    s_mov_b32 s58, 400000
F_UA1:
    ds_read_b32 v4, v63 offset:160
    ds_read_b128 v[8:11], v163 offset:0
    ds_read_b128 v[12:15], v163 offset:1024
    ds_read_b128 v[16:19], v163 offset:16384
    ds_read_b128 v[20:23], v163 offset:17408
    s_sub_u32 s58, s58, 1
    s_waitcnt lgkmcnt(4)
    s_cbranch_scc1 F_UA2
    v_readfirstlane_b32 s57, v4
    s_andn2_b32 s57, 0xdddd, s57
    s_cbranch_scc1 F_UA1
F_UA2:
    ds_read_b32 v5, v63 offset:160
    ds_read_b128 v[24:27], v163 offset:32768
    ds_read_b128 v[28:31], v163 offset:33792
    s_waitcnt lgkmcnt(3)
    s_branch F_UAC
F_UB:
    s_mov_b32 s58, 400000
F_UB1:
    ds_read_b32 v5, v63 offset:160
    ds_read_b128 v[24:27], v163 offset:32768
    ds_read_b128 v[28:31], v163 offset:33792
    s_sub_u32 s58, s58, 1
    s_waitcnt lgkmcnt(2)
    s_cbranch_scc1 F_UBC
    v_readfirstlane_b32 s57, v5
    s_bitcmp0_b32 s57, 16
    s_cbranch_scc1 F_UB1
    s_branch F_UBC
F_FIN:
    s_cmp_eq_u32 s59, 0
    s_cbranch_scc1 F_B3
    buffer_store_dwordx4 v[56:59], v1, s[44:47], s59 offen sc1
    s_mov_b32 s59, 0
F_B3:
    s_endpgm
F_S:
    s_lshl_b32 s65, s64, 12
    s_add_u32 s65, s65, 131072
    v_lshrrev_b32 v6, 2, v0
    v_and_b32 v7, 7, v6
    v_lshlrev_b32 v7, 4, v7
    v_lshl_add_u32 v7, v6, 8, v7
    v_and_b32 v6, 3, v0
    v_lshl_add_u32 v7, v6, 2, v7
    v_add_u32 v8, s65, v7
    v_xor_b32 v9, 16, v8
    v_xor_b32 v10, 32, v8
    v_xor_b32 v11, 48, v8
    v_xor_b32 v12, 64, v8
    v_xor_b32 v13, 80, v8
    v_xor_b32 v14, 96, v8
    v_xor_b32 v15, 112, v8
    v_lshrrev_b32 v6, 4, v0
    v_and_b32 v7, 15, v0
    v_xor_b32 v7, v7, v6
    v_lshlrev_b32 v7, 4, v7
    v_lshl_add_u32 v7, v6, 8, v7
    v_add_u32 v16, s65, v7
    v_xor_b32 v17, 64, v16
    v_mov_b32 v160, 155648
    s_lshl_b32 s66, s64, 2
    s_add_u32 s66, s66, 155680
    v_mov_b32 v161, s66
    s_mov_b32 s67, 0x3fb8aa3b
    s_mov_b32 s16, 400000
    s_waitcnt vmcnt(0)
    v_lshlrev_b32 v6, 16, v18
    v_readfirstlane_b32 s15, v19
    s_lshl_b32 s15, s15, 16
    v_mul_f32 v6, s67, v6
    v_exp_f32 v6, v6
    s_nop 0
    v_cvt_pk_bf16_f32 v6, v6, v6
    v_and_b32 v6, 0xffff0000, v6
    s_waitcnt vmcnt(0)
    v_lshlrev_b32 v2, 16, v2
    v_lshlrev_b32 v3, 16, v3
    v_lshlrev_b32 v4, 16, v4
    v_lshlrev_b32 v5, 16, v5
    v_mul_f32 v2, s67, v2
    v_exp_f32 v2, v2
    v_mul_f32 v3, v3, v6
    v_mul_f32 v4, v4, v6
    v_mul_f32 v5, v5, v6
    v_cvt_pk_bf16_f32 v2, v2, v2
    v_and_b32 v2, 0xffff0000, v2
    v_mul_f32 v2, v2, v6
    v_mul_f32 v3, 0.15915494, v3
    v_mul_f32 v2, s67, v2
    v_add_f32 v4, v4, v4
    v_add_f32 v5, v5, v5
    v_mul_f32 v28, 0xbf800000, v2
    v_mul_f32 v29, 0x3f800000, v3
    v_mul_f32 v31, 0xc1000000, v2
    v_mul_f32 v32, 0x41000000, v3
    v_mul_f32 v34, 0xc3800000, v2
    v_mul_f32 v35, 0x43800000, v3
    v_exp_f32 v28, v28
    v_fract_f32 v29, v29
    v_exp_f32 v31, v31
    v_fract_f32 v32, v32
    v_exp_f32 v34, v34
    v_fract_f32 v35, v35
    v_cos_f32 v30, v29
    v_sin_f32 v29, v29
    v_cos_f32 v33, v32
    v_sin_f32 v32, v32
    v_cos_f32 v36, v35
    v_sin_f32 v35, v35
    v_mul_f32 v18, v28, v30
    v_mul_f32 v19, v28, v29
    v_mul_f32 v20, v31, v33
    v_mul_f32 v21, v31, v32
    v_mul_f32 v22, v34, v36
    v_mul_f32 v23, v34, v35
    v_mul_f32 v28, v18, v18
    v_mul_f32 v29, v18, v19
    v_fma_f32 v24, -v19, v19, v28
TCH_10:
ST0_12:
    s_cbranch_execz F_S0
    v_fma_f32 v25, v19, v18, v29
    v_mul_f32 v28, v24, v24
    v_mul_f32 v29, v24, v25
    v_fma_f32 v26, -v25, v25, v28
    v_fma_f32 v27, v25, v24, v29
    v_mov_b32 v52, 0x3f80
    v_cvt_pk_bf16_f32 v53, v20, v21
    v_cvt_pk_bf16_f32 v84, v4, -v5
    v_mul_f32 v28, v20, v20
    v_mul_f32 v30, v4, v18
    v_mul_f32 v29, v20, v21
    v_mul_f32 v31, v4, v19
    v_fma_f32 v40, -v21, v21, v28
    v_fma_f32 v48, -v5, v19, v30
    v_fma_f32 v41, v21, v20, v29
    v_fma_f32 v49, v5, v18, v31
    v_cvt_pk_bf16_f32 v54, v40, v41
    v_cvt_pk_bf16_f32 v85, v48, -v49
    v_mul_f32 v28, v40, v20
    v_mul_f32 v30, v48, v18
    v_mul_f32 v29, v40, v21
    v_mul_f32 v31, v48, v19
    v_fma_f32 v42, -v41, v21, v28
    v_fma_f32 v50, -v49, v19, v30
    v_fma_f32 v43, v41, v20, v29
    v_fma_f32 v51, v49, v18, v31
    v_cvt_pk_bf16_f32 v55, v42, v43
    v_cvt_pk_bf16_f32 v86, v50, -v51
    v_mul_f32 v28, v42, v20
    v_mul_f32 v30, v50, v18
    v_mul_f32 v29, v42, v21
    v_mul_f32 v31, v50, v19
    v_fma_f32 v40, -v43, v21, v28
    v_fma_f32 v48, -v51, v19, v30
    v_fma_f32 v41, v43, v20, v29
    v_fma_f32 v49, v51, v18, v31
    v_cvt_pk_bf16_f32 v56, v40, v41
    v_cvt_pk_bf16_f32 v87, v48, -v49
    v_mul_f32 v28, v40, v20
    v_mul_f32 v30, v48, v18
    v_mul_f32 v29, v40, v21
    v_mul_f32 v31, v48, v19
    v_fma_f32 v42, -v41, v21, v28
    v_fma_f32 v50, -v49, v19, v30
    v_fma_f32 v43, v41, v20, v29
    v_fma_f32 v51, v49, v18, v31
    v_cvt_pk_bf16_f32 v57, v42, v43
    v_cvt_pk_bf16_f32 v88, v50, -v51
    v_mul_f32 v28, v42, v20
    v_mul_f32 v30, v50, v18
    v_mul_f32 v29, v42, v21
    v_mul_f32 v31, v50, v19
    v_fma_f32 v40, -v43, v21, v28
    v_fma_f32 v48, -v51, v19, v30
    v_fma_f32 v41, v43, v20, v29
    v_fma_f32 v49, v51, v18, v31
    v_cvt_pk_bf16_f32 v58, v40, v41
    v_cvt_pk_bf16_f32 v89, v48, -v49
    v_mul_f32 v28, v40, v20
    v_mul_f32 v30, v48, v18
    v_mul_f32 v29, v40, v21
    v_mul_f32 v31, v48, v19
    v_fma_f32 v42, -v41, v21, v28
    v_fma_f32 v50, -v49, v19, v30
    v_fma_f32 v43, v41, v20, v29
    v_fma_f32 v51, v49, v18, v31
    v_cvt_pk_bf16_f32 v59, v42, v43
    v_cvt_pk_bf16_f32 v90, v50, -v51
    v_mul_f32 v28, v42, v20
    v_mul_f32 v30, v50, v18
    v_mul_f32 v29, v42, v21
    v_mul_f32 v31, v50, v19
    v_fma_f32 v40, -v43, v21, v28
    v_fma_f32 v48, -v51, v19, v30
    v_fma_f32 v41, v43, v20, v29
    v_fma_f32 v49, v51, v18, v31
    v_cvt_pk_bf16_f32 v60, v40, v41
    v_cvt_pk_bf16_f32 v91, v48, -v49
    v_mul_f32 v28, v40, v20
    v_mul_f32 v30, v4, v22
    v_mul_f32 v29, v40, v21
    v_mul_f32 v31, v4, v23
    v_fma_f32 v42, -v41, v21, v28
    v_fma_f32 v44, -v5, v23, v30
    v_fma_f32 v43, v41, v20, v29
    v_fma_f32 v45, v5, v22, v31
    v_cvt_pk_bf16_f32 v61, v42, v43
    v_cvt_pk_bf16_f32 v92, v44, -v45
    v_mul_f32 v28, v42, v20
    v_mul_f32 v30, v44, v24
    v_mul_f32 v29, v42, v21
    v_mul_f32 v31, v44, v25
    v_fma_f32 v40, -v43, v21, v28
    v_fma_f32 v50, -v45, v25, v30
    v_fma_f32 v41, v43, v20, v29
    v_fma_f32 v51, v45, v24, v31
    v_cvt_pk_bf16_f32 v62, v40, v41
    v_cvt_pk_bf16_f32 v93, v50, -v51
    v_mul_f32 v28, v40, v20
    v_mul_f32 v30, v50, v24
    v_mul_f32 v29, v40, v21
    v_mul_f32 v31, v50, v25
    v_fma_f32 v42, -v41, v21, v28
    v_fma_f32 v48, -v51, v25, v30
    v_fma_f32 v43, v41, v20, v29
    v_fma_f32 v49, v51, v24, v31
    v_cvt_pk_bf16_f32 v63, v42, v43
    v_cvt_pk_bf16_f32 v94, v48, -v49
    v_mul_f32 v28, v42, v20
    v_mul_f32 v30, v48, v24
    v_mul_f32 v29, v42, v21
    v_mul_f32 v31, v48, v25
    v_fma_f32 v40, -v43, v21, v28
    v_fma_f32 v50, -v49, v25, v30
    v_fma_f32 v41, v43, v20, v29
    v_fma_f32 v51, v49, v24, v31
    v_cvt_pk_bf16_f32 v64, v40, v41
    v_cvt_pk_bf16_f32 v95, v50, -v51
    v_mul_f32 v28, v40, v20
    v_mul_f32 v30, v50, v24
    v_mul_f32 v29, v40, v21
    v_mul_f32 v31, v50, v25
    v_fma_f32 v42, -v41, v21, v28
    v_fma_f32 v48, -v51, v25, v30
    v_fma_f32 v43, v41, v20, v29
    v_fma_f32 v49, v51, v24, v31
    v_cvt_pk_bf16_f32 v65, v42, v43
    v_cvt_pk_bf16_f32 v96, v48, -v49
    v_mul_f32 v28, v42, v20
    v_mul_f32 v30, v44, v22
    v_mul_f32 v29, v42, v21
    v_mul_f32 v31, v44, v23
    v_fma_f32 v40, -v43, v21, v28
    v_fma_f32 v46, -v45, v23, v30
    v_fma_f32 v41, v43, v20, v29
    v_fma_f32 v47, v45, v22, v31
    v_cvt_pk_bf16_f32 v66, v40, v41
    v_cvt_pk_bf16_f32 v100, v46, -v47
    v_mul_f32 v28, v40, v20
    v_mul_f32 v30, v46, v26
    v_mul_f32 v29, v40, v21
    v_mul_f32 v31, v46, v27
    v_fma_f32 v42, -v41, v21, v28
    v_fma_f32 v50, -v47, v27, v30
    v_fma_f32 v43, v41, v20, v29
    v_fma_f32 v51, v47, v26, v31
    v_cvt_pk_bf16_f32 v67, v42, v43
    v_cvt_pk_bf16_f32 v101, v50, -v51
    v_mul_f32 v28, v42, v20
    v_mul_f32 v30, v50, v26
    v_mul_f32 v29, v42, v21
    v_mul_f32 v31, v50, v27
    v_fma_f32 v40, -v43, v21, v28
    v_fma_f32 v48, -v51, v27, v30
    v_fma_f32 v41, v43, v20, v29
    v_fma_f32 v49, v51, v26, v31
    v_cvt_pk_bf16_f32 v68, v40, v41
    v_cvt_pk_bf16_f32 v102, v48, -v49
TCH_11:
ST0_13:
    s_cbranch_execz F_S0
    v_mul_f32 v28, v40, v20
    v_mul_f32 v30, v46, v22
    v_mul_f32 v29, v40, v21
    v_mul_f32 v31, v46, v23
    v_fma_f32 v42, -v41, v21, v28
    v_fma_f32 v44, -v47, v23, v30
    v_fma_f32 v43, v41, v20, v29
    v_fma_f32 v45, v47, v22, v31
    v_cvt_pk_bf16_f32 v69, v42, v43
    v_cvt_pk_bf16_f32 v103, v44, -v45
    v_mul_f32 v28, v42, v20
    v_mul_f32 v30, v44, v26
    v_mul_f32 v29, v42, v21
    v_mul_f32 v31, v44, v27
    v_fma_f32 v40, -v43, v21, v28
    v_fma_f32 v50, -v45, v27, v30
    v_fma_f32 v41, v43, v20, v29
    v_fma_f32 v51, v45, v26, v31
    v_cvt_pk_bf16_f32 v70, v40, v41
    v_cvt_pk_bf16_f32 v104, v50, -v51
    v_mul_f32 v28, v40, v20
    v_mul_f32 v30, v50, v26
    v_mul_f32 v29, v40, v21
    v_mul_f32 v31, v50, v27
    v_fma_f32 v42, -v41, v21, v28
    v_fma_f32 v48, -v51, v27, v30
    v_fma_f32 v43, v41, v20, v29
    v_fma_f32 v49, v51, v26, v31
    v_cvt_pk_bf16_f32 v71, v42, v43
    v_cvt_pk_bf16_f32 v105, v48, -v49
    v_mul_f32 v28, v42, v20
    v_mul_f32 v30, v44, v22
    v_mul_f32 v29, v42, v21
    v_mul_f32 v31, v44, v23
    v_fma_f32 v40, -v43, v21, v28
    v_fma_f32 v46, -v45, v23, v30
    v_fma_f32 v41, v43, v20, v29
    v_fma_f32 v47, v45, v22, v31
    v_cvt_pk_bf16_f32 v72, v40, v41
    v_cvt_pk_bf16_f32 v106, v46, -v47
    v_mul_f32 v28, v40, v20
    v_mul_f32 v30, v46, v20
    v_mul_f32 v29, v40, v21
    v_mul_f32 v31, v46, v21
    v_fma_f32 v42, -v41, v21, v28
    v_fma_f32 v50, -v47, v21, v30
    v_fma_f32 v43, v41, v20, v29
    v_fma_f32 v51, v47, v20, v31
    v_cvt_pk_bf16_f32 v73, v42, v43
    v_cvt_pk_bf16_f32 v107, v50, -v51
    v_mul_f32 v28, v42, v20
    v_mul_f32 v30, v46, v22
    v_mul_f32 v29, v42, v21
    v_mul_f32 v31, v46, v23
    v_fma_f32 v40, -v43, v21, v28
    v_fma_f32 v44, -v47, v23, v30
    v_fma_f32 v41, v43, v20, v29
    v_fma_f32 v45, v47, v22, v31
    v_cvt_pk_bf16_f32 v74, v40, v41
    v_cvt_pk_bf16_f32 v108, v44, -v45
    v_mul_f32 v28, v40, v20
    v_mul_f32 v30, v44, v20
    v_mul_f32 v29, v40, v21
    v_mul_f32 v31, v44, v21
    v_fma_f32 v42, -v41, v21, v28
    v_fma_f32 v48, -v45, v21, v30
    v_fma_f32 v43, v41, v20, v29
    v_fma_f32 v49, v45, v20, v31
    v_cvt_pk_bf16_f32 v75, v42, v43
    v_cvt_pk_bf16_f32 v109, v48, -v49
    v_mul_f32 v28, v42, v20
    v_mul_f32 v30, v44, v22
    v_mul_f32 v29, v42, v21
    v_mul_f32 v31, v44, v23
    v_fma_f32 v40, -v43, v21, v28
    v_fma_f32 v46, -v45, v23, v30
    v_fma_f32 v41, v43, v20, v29
    v_fma_f32 v47, v45, v22, v31
    v_cvt_pk_bf16_f32 v76, v40, v41
    v_cvt_pk_bf16_f32 v110, v46, -v47
    v_mul_f32 v28, v40, v20
    v_mul_f32 v30, v46, v20
    v_mul_f32 v29, v40, v21
    v_mul_f32 v31, v46, v21
    v_fma_f32 v42, -v41, v21, v28
    v_fma_f32 v50, -v47, v21, v30
    v_fma_f32 v43, v41, v20, v29
    v_fma_f32 v51, v47, v20, v31
    v_cvt_pk_bf16_f32 v77, v42, v43
    v_cvt_pk_bf16_f32 v111, v50, -v51
    v_mul_f32 v28, v42, v20
    v_mul_f32 v30, v46, v22
    v_mul_f32 v29, v42, v21
    v_mul_f32 v31, v46, v23
    v_fma_f32 v40, -v43, v21, v28
    v_fma_f32 v44, -v47, v23, v30
    v_fma_f32 v41, v43, v20, v29
    v_fma_f32 v45, v47, v22, v31
    v_cvt_pk_bf16_f32 v78, v40, v41
    v_cvt_pk_bf16_f32 v112, v44, -v45
    v_mul_f32 v28, v40, v20
    v_mul_f32 v30, v44, v20
    v_mul_f32 v29, v40, v21
    v_mul_f32 v31, v44, v21
    v_fma_f32 v42, -v41, v21, v28
    v_fma_f32 v48, -v45, v21, v30
    v_fma_f32 v43, v41, v20, v29
    v_fma_f32 v49, v45, v20, v31
    v_cvt_pk_bf16_f32 v79, v42, v43
    v_cvt_pk_bf16_f32 v113, v48, -v49
    v_mul_f32 v28, v42, v20
    v_and_b32 v148, 7, v0
    v_mul_f32 v29, v42, v21
    v_lshlrev_b32 v148, 13, v148
    v_fma_f32 v40, -v43, v21, v28
    v_and_b32 v149, 8, v0
    v_fma_f32 v41, v43, v20, v29
    v_lshl_add_u32 v148, v149, 9, v148
    v_cvt_pk_bf16_f32 v80, v40, v41
    v_and_b32 v149, 16, v0
    v_mul_f32 v28, v40, v20
    v_add_u32 v148, v148, v149
    v_mul_f32 v29, v40, v21
    s_mov_b64 s[48:49], s[26:27]
    s_mov_b32 s50, 0x200000
    s_lshl_b32 s22, s5, 16
    s_lshl_b32 s23, s4, 7
    s_add_u32 s22, s22, s23
    s_lshl_b32 s23, s64, 5
    s_add_u32 s22, s22, s23
    v_and_b32 v154, 15, v0
    v_fma_f32 v42, -v41, v21, v28
    v_lshlrev_b32 v154, 4, v154
    v_fma_f32 v43, v41, v20, v29
    v_and_b32 v149, 16, v0
    v_cvt_pk_bf16_f32 v81, v42, v43
    v_lshl_add_u32 v154, v149, 11, v154
    v_mul_f32 v28, v42, v20
    v_mov_b32 v150, -1
    v_mul_f32 v29, v42, v21
    v_mov_b32 v151, -1
    v_fma_f32 v40, -v43, v21, v28
    v_mov_b32 v152, -1
    v_fma_f32 v41, v43, v20, v29
    v_mov_b32 v153, -1
    v_cvt_pk_bf16_f32 v82, v40, v41
    s_lshl_b32 s17, s6, 16
    s_lshl_b32 s18, s7, 12
    s_add_u32 s17, s17, s18
    s_lshl_b32 s18, s9, 15
    s_add_u32 s17, s17, s18
    s_lshl_b32 s18, s10, 11
    s_add_u32 s17, s17, s18
    s_add_u32 s17, s17, 0x20000
    s_add_u32 s18, s17, 0x200000
    s_lshl_b32 s19, s4, 18
    s_lshl_b32 s20, s64, 16
    s_add_u32 s19, s19, s20
    s_lshl_b32 s20, s5, 8
    s_add_u32 s19, s19, s20
    s_add_u32 s19, s19, 0x420000
    v_lshlrev_b32 v1, 4, v0
    v_mul_f32 v28, v40, v20
    v_add_u32 v35, s65, v1
    v_mul_f32 v29, v40, v21
    v_xor_b32 v36, 4096, v35
    v_fma_f32 v42, -v41, v21, v28
    s_cmp_eq_u32 s10, 0
    s_cselect_b32 s15, s15, 0
    v_cmp_eq_u32 vcc, 0, v0
    v_fma_f32 v43, v41, v20, v29
TCE_6:
ST0_14:
    s_cbranch_execz ST0_17
    v_mov_b32 v2, s15
    v_cvt_pk_bf16_f32 v83, v42, v43
    v_mov_b32 v3, 0
    v_mov_b32 v4, 0
    v_mov_b32 v5, 0
    v_cndmask_b32 v2, 0, v2, vcc
    s_mul_i32 s12, s9, 7600
    s_add_u32 s12, s12, 131072
    s_add_u32 s14, s12, 448
    s_cmp_eq_u32 s10, 0
    s_cbranch_scc0 F_NH1
    v_lshrrev_b32 v34, 5, v0
    v_lshlrev_b32 v34, 8, v34
    v_and_b32 v37, 15, v0
    v_lshl_add_u32 v34, v37, 3, v34
    v_bfe_u32 v37, v0, 4, 1
    v_lshl_add_u32 v34, v37, 2, v34
    v_xor_b32 v34, 4, v34
    s_branch F_NHX
F_NH1:
    v_lshrrev_b32 v34, 4, v0
    v_cmp_eq_u32 vcc, 3, v34
    s_nop 1
    v_addc_co_u32 v34, vcc, 2, v34, vcc
    v_lshlrev_b32 v34, 8, v34
    v_and_b32 v37, 15, v0
    v_lshl_add_u32 v34, v37, 3, v34
F_NHX:
    v_lshl_add_u32 v34, v34, 1, s14
    s_lshl_b32 s13, s64, 14
    s_mul_i32 s14, s10, 15872
    s_sub_u32 s13, s13, s14
    v_and_b32 v37, 32, v0
    v_lshl_add_u32 v44, v37, 7, s13
    v_and_b32 v37, 31, v0
    v_lshl_add_u32 v44, v37, 4, v44
    v_xor_b32 v50, 512, v44
    s_lshl_b32 s13, s9, 6
    s_add_u32 s13, s13, s10
    s_lshl_b32 s13, s13, 5
    v_and_b32 v45, 2, v0
    v_lshl_add_u32 v45, v45, 11, s13
    v_and_b32 v37, 56, v0
    v_lshl_add_u32 v45, v37, 4, v45
    v_and_b32 v37, 1, v0
    v_lshl_add_u32 v45, v37, 6, v45
    v_and_b32 v37, 4, v0
    v_lshl_add_u32 v45, v37, 2, v45
    v_mov_b32 v40, 0
    v_mov_b32 v41, 0
    v_mov_b32 v42, 0
    v_mov_b32 v43, 0
    v_lshrrev_b32 v39, 5, v0
    v_and_b32 v37, 3, v0
    v_mul_u32_u24 v37, 4256, v37
    v_bfe_u32 v38, v0, 2, 3
    v_lshl_add_u32 v37, v38, 3, v37
    v_lshl_add_u32 v37, v39, 6, v37
    s_mul_i32 s13, s9, 17024
    s_add_u32 s13, s13, 16392
    v_add_u32 v18, s13, v37
    v_add_u32 v19, 2048, v18
    v_and_b32 v37, 31, v0
    v_xor_b32 v38, 1, v39
    v_lshl_add_u32 v37, v38, 2, v37
    v_lshl_add_u32 v20, v37, 4, s12
    v_min_u32 v24, 432, v1
    v_add_u32 v24, s12, v24
    s_mul_i32 s13, s64, 8512
    s_add_u32 s13, s13, 16392
    s_sub_u32 s14, 14, s10
    v_bfe_u32 v37, v0, 4, 1
    v_mul_u32_u24 v37, 4256, v37
    v_and_b32 v38, 15, v0
    v_min_u32 v38, s14, v38
    v_lshl_add_u32 v37, v38, 2, v37
    v_add_u32 v25, s13, v37
    s_lshl_b32 s13, s64, 10
    s_add_u32 s13, s13, 16448
    v_add_u32 v21, s13, v1
    v_add_u32 v30, 4, v21
    v_add_u32 v31, 4260, v21
    v_add_u32 v32, 17028, v21
    v_add_u32 v33, 21284, v21
    s_lshl_b32 s13, s64, 11
    v_and_b32 v37, 7, v0
    v_lshlrev_b32 v37, 4, v37
    v_and_b32 v38, 56, v0
    v_lshl_add_u32 v22, v38, 5, v37
    s_sub_u32 s14, s13, 4
    v_mov_b32 v37, s14
    v_cmp_eq_u32 vcc, 0, v0
    s_nop 1
    v_cndmask_b32 v23, -1, v37, vcc
    v_bfe_u32 v37, v0, 4, 1
    v_lshlrev_b32 v37, 2, v37
    v_and_b32 v38, 7, v0
    v_xor_b32 v37, v37, v38
    v_lshlrev_b32 v37, 4, v37
    v_lshrrev_b32 v38, 3, v0
    v_lshl_add_u32 v26, v38, 10, v37
    v_add_u32 v27, 7168, v26
    v_add_u32 v28, 14336, v26
    v_add_u32 v29, 21504, v26
    s_lshl_b32 s14, s8, 13
    s_add_u32 s14, s14, 0x420000
    s_add_u32 s13, s13, s14
    s_mov_b64 s[56:57], s[24:25]
    s_mov_b32 s58, 0x80000
    s_mov_b64 s[52:53], s[40:41]
    s_mov_b32 s54, 0x400000
    s_lshl_b32 s11, s64, 15
    s_lshl_b32 s15, s7, 7
    s_add_u32 s11, s11, s15
    s_lshl_b32 s15, s64, 12
    s_mov_b32 s60, 0xffffffff
    s_mov_b32 s61, 0
    s_mov_b32 s62, 0xffffffff
    s_mov_b32 s63, 0xaaaaaaaa
    s_cmp_lg_u32 s64, 0
    s_cbranch_scc1 F_NY
    v_and_b32 v37, 7, v0
    v_lshrrev_b32 v38, 3, v0
    v_lshlrev_b32 v46, 15, v38
    v_lshl_add_u32 v46, v37, 4, v46
    v_xor_b32 v39, v37, v38
    v_lshlrev_b32 v39, 4, v39
    v_add_u32 v39, 131072, v39
    v_lshl_add_u32 v47, v38, 7, v39
    v_lshl_add_u32 v48, v37, 7, v39
    v_lshlrev_b32 v49, 4, v37
    v_and_b32 v37, 8, v0
    v_lshl_add_u32 v49, v37, 13, v49
    v_and_b32 v37, 48, v0
    v_lshl_add_u32 v49, v37, 9, v49
F_NY:
    s_mov_b32 s16, 400000
    s_branch F_UWC
F_UW:
    s_nop 15
    s_nop 15
    s_nop 15
    s_nop 15
F_UWC:
    ds_read_b32 v164, v160
    s_waitcnt lgkmcnt(0)
    v_readfirstlane_b32 s66, v164
    s_sub_u32 s16, s16, 1
    s_cselect_b32 s66, -1, s66
    s_andn2_b32 s66, 0x08080808, s66
    s_cbranch_scc1 F_UW
    s_mov_b32 exec_hi, 0
    buffer_load_dwordx4 v[132:135], v148, s[48:51], s22 offen offset:0
    buffer_load_dwordx4 v[136:139], v148, s[48:51], s22 offen offset:1024
    buffer_load_dwordx4 v[140:143], v148, s[48:51], s22 offen offset:2048
    buffer_load_dwordx4 v[144:147], v148, s[48:51], s22 offen offset:3072
    s_mov_b32 exec_hi, -1
    s_mov_b32 s16, 400000
    s_branch F_SPFC
F_SPF:
    s_nop 15
    s_nop 15
    s_nop 15
    s_nop 15
F_SPFC:
    ds_read_b128 v[164:167], v160 offset:64
    s_waitcnt lgkmcnt(0)
    v_min3_u32 v164, v164, v165, v166
    v_min_u32 v164, v164, v167
    s_nop 0
    v_readfirstlane_b32 s66, v164
    s_sub_u32 s16, s16, 1
    s_cselect_b32 s66, 1, s66
    s_cmp_lt_u32 s66, 1
    s_cbranch_scc1 F_SPF
    ds_write2_b32 v8, v84, v92 offset1:32
    ds_write2_b32 v9, v85, v92 offset1:32
    ds_write2_b32 v10, v86, v93 offset1:32
    ds_write2_b32 v11, v87, v94 offset1:32
    ds_write2_b32 v12, v88, v94 offset1:32
    ds_write2_b32 v13, v89, v94 offset1:32
    ds_write2_b32 v14, v90, v95 offset1:32
    ds_write2_b32 v15, v91, v96 offset1:32
    ds_read_b128 v[84:87], v16 offset:0
    ds_read_b128 v[88:91], v17 offset:1024
    ds_read_b128 v[92:95], v16 offset:2048
    ds_read_b128 v[96:99], v17 offset:3072
    ds_write2_b32 v8, v52, v60 offset1:32
TCE_7:
ST0_15:
    s_cbranch_execz F_DE
    ds_write2_b32 v9, v53, v61 offset1:32
    ds_write2_b32 v10, v54, v62 offset1:32
    ds_write2_b32 v11, v55, v63 offset1:32
    ds_write2_b32 v12, v56, v64 offset1:32
    ds_write2_b32 v13, v57, v65 offset1:32
    ds_write2_b32 v14, v58, v66 offset1:32
    ds_write2_b32 v15, v59, v67 offset1:32
    ds_read_b128 v[52:55], v16 offset:0
    ds_read_b128 v[56:59], v17 offset:1024
    ds_read_b128 v[60:63], v16 offset:2048
    ds_read_b128 v[64:67], v17 offset:3072
    ds_write2_b32 v8, v100, v106 offset1:32
    ds_write2_b32 v9, v101, v107 offset1:32
    ds_write2_b32 v10, v102, v108 offset1:32
    ds_write2_b32 v11, v102, v109 offset1:32
    ds_write2_b32 v12, v103, v110 offset1:32
    ds_write2_b32 v13, v104, v111 offset1:32
    ds_write2_b32 v14, v105, v112 offset1:32
    ds_write2_b32 v15, v105, v113 offset1:32
    ds_read_b128 v[100:103], v16 offset:0
    ds_read_b128 v[104:107], v17 offset:1024
    ds_read_b128 v[108:111], v16 offset:2048
    ds_read_b128 v[112:115], v17 offset:3072
    s_waitcnt lgkmcnt(12)
    v_mfma_f32_16x16x32_bf16 v[116:119], v[84:87], v[52:55], v[2:5]
    v_mfma_f32_16x16x32_bf16 v[116:119], v[88:91], v[56:59], v[116:119]
    v_mfma_f32_16x16x32_bf16 v[116:119], v[92:95], v[60:63], v[116:119]
    v_mfma_f32_16x16x32_bf16 v[116:119], v[96:99], v[64:67], v[116:119]
    ds_write2_b32 v8, v68, v76 offset1:32
    ds_write2_b32 v9, v69, v77 offset1:32
    ds_write2_b32 v10, v70, v78 offset1:32
    ds_write2_b32 v11, v71, v79 offset1:32
    ds_write2_b32 v12, v72, v80 offset1:32
    ds_write2_b32 v13, v73, v81 offset1:32
    ds_write2_b32 v14, v74, v82 offset1:32
    ds_write2_b32 v15, v75, v83 offset1:32
    ds_read_b128 v[68:71], v16 offset:0
    ds_read_b128 v[72:75], v17 offset:1024
    ds_read_b128 v[76:79], v16 offset:2048
    ds_read_b128 v[80:83], v17 offset:3072
    s_waitcnt lgkmcnt(12)
    v_mfma_f32_16x16x32_bf16 v[124:127], v[100:103], v[52:55], 0
    v_mfma_f32_16x16x32_bf16 v[124:127], v[104:107], v[56:59], v[124:127]
    v_mfma_f32_16x16x32_bf16 v[124:127], v[108:111], v[60:63], v[124:127]
    v_mfma_f32_16x16x32_bf16 v[124:127], v[112:115], v[64:67], v[124:127]
    s_waitcnt lgkmcnt(0)
    v_mfma_f32_16x16x32_bf16 v[128:131], v[100:103], v[68:71], 0
    v_mfma_f32_16x16x32_bf16 v[128:131], v[104:107], v[72:75], v[128:131]
    v_mfma_f32_16x16x32_bf16 v[128:131], v[108:111], v[76:79], v[128:131]
    v_mfma_f32_16x16x32_bf16 v[128:131], v[112:115], v[80:83], v[128:131]
    v_mfma_f32_16x16x32_bf16 v[120:123], v[84:87], v[68:71], 0
    v_mfma_f32_16x16x32_bf16 v[120:123], v[88:91], v[72:75], v[120:123]
    v_mfma_f32_16x16x32_bf16 v[120:123], v[92:95], v[76:79], v[120:123]
    v_mfma_f32_16x16x32_bf16 v[120:123], v[96:99], v[80:83], v[120:123]
    s_cmp_eq_u32 s10, 0
    s_cbranch_scc0 F_NH2
    ds_write_b128 v35, v[124:127]
    s_nop 0
    ds_write_b128 v35, v[128:131] offset:1024
    s_branch F_NH3
F_NH2:
    ds_write_b128 v35, v[116:119]
    s_nop 4
    ds_write_b128 v35, v[120:123] offset:1024
F_NH3:
    s_waitcnt vmcnt(0)
    v_swap_b32 v133, v136
    v_swap_b32 v134, v140
    v_swap_b32 v135, v144
    v_swap_b32 v138, v141
    v_swap_b32 v139, v145
    v_swap_b32 v143, v146
    s_mov_b32 exec_hi, 0
    buffer_store_dwordx4 v[132:135], v154, s[44:47], s19 offen sc1
    s_add_u32 s19, s19, 8192
    buffer_store_dwordx4 v[136:139], v154, s[44:47], s19 offen sc1
    s_add_u32 s19, s19, 8192
    buffer_store_dwordx4 v[140:143], v154, s[44:47], s19 offen sc1
    s_add_u32 s19, s19, 8192
    buffer_store_dwordx4 v[144:147], v154, s[44:47], s19 offen sc1
    s_mov_b32 exec_hi, -1
    buffer_store_dwordx4 v[150:153], v1, s[44:47], s17 offen offset:0 sc1
    buffer_store_dwordx4 v[150:153], v1, s[44:47], s17 offen offset:1024 sc1
    buffer_store_dwordx4 v[150:153], v1, s[44:47], s18 offen offset:0 sc1
    buffer_store_dwordx4 v[150:153], v1, s[44:47], s18 offen offset:1024 sc1
    s_lshl_b32 s21, s8, 7
    s_add_u32 s21, s21, 0x620000
    s_cmp_lg_u32 s64, 0
    s_cbranch_scc1 F_HM
    s_mov_b64 exec, 1
    buffer_store_dwordx4 v[150:153], off, s[44:47], s21 sc1
    s_mov_b64 exec, -1
F_HM:
    s_waitcnt lgkmcnt(0)
    s_mov_b64 s[36:37], s[42:43]
    s_mov_b32 s38, 256
    s_mov_b32 s39, 0x00020000
    s_and_b32 s17, s4, 3
    s_lshl_b32 s17, s17, 6
    s_and_b32 s18, s4, 4
    s_add_u32 s17, s17, s18
    s_add_u32 s17, s17, 4
    v_mov_b32 v162, 1
    s_mov_b32 s16, 400000
    s_waitcnt lgkmcnt(0)
    ds_write_b32 v161, v162
F_HS1:
    ds_read_b128 v[164:167], v160 offset:32
    s_waitcnt lgkmcnt(0)
    v_min3_u32 v164, v164, v165, v166
    v_min_u32 v164, v164, v167
    s_nop 0
    v_readfirstlane_b32 s66, v164
    s_sub_u32 s16, s16, 1
    s_cselect_b32 s66, 1, s66
    s_cmp_lt_u32 s66, 1
    s_cbranch_scc1 F_HS1
    ds_read_b128 v[84:87], v36
    ds_read_b128 v[88:91], v36 offset:1024
    s_cmp_eq_u32 s10, 0
    s_waitcnt lgkmcnt(0)
    s_cbranch_scc0 F_NH1B
    v_pk_add_f32 v[84:85], v[84:85], v[116:117]
    v_pk_add_f32 v[86:87], v[86:87], v[118:119]
    v_pk_add_f32 v[88:89], v[88:89], v[120:121]
    v_pk_add_f32 v[90:91], v[90:91], v[122:123]
    v_cvt_pk_bf16_f32 v92, v87, v86
    v_cvt_pk_bf16_f32 v93, v85, v84
    v_cvt_pk_bf16_f32 v94, v91, v90
    v_cvt_pk_bf16_f32 v95, v89, v88
    s_waitcnt vmcnt(0)
    v_mov_b32 v162, 2
    s_mov_b32 s16, 400000
    s_waitcnt lgkmcnt(0)
    ds_write_b32 v161, v162
F_HS2a:
    ds_read_b128 v[164:167], v160 offset:32
    ds_read_b128 v[64:67], v160 offset:96
    ds_read_b128 v[68:71], v160 offset:112
    s_waitcnt lgkmcnt(0)
    v_min3_u32 v164, v164, v64, v65
    v_min3_u32 v164, v164, v66, v67
    v_min3_u32 v164, v164, v68, v69
    v_min3_u32 v164, v164, v70, v71
    v_min3_u32 v164, v164, v165, v166
    v_min_u32 v164, v164, v167
    s_nop 0
    v_readfirstlane_b32 s66, v164
    s_sub_u32 s16, s16, 1
    s_cselect_b32 s66, 2, s66
    s_cmp_lt_u32 s66, 2
    s_cbranch_scc1 F_HS2a
    ds_write_b64 v34, v[92:93]
    ds_write_b64 v34, v[94:95] offset:256
    s_branch F_NHY
F_NH1B:
    v_pk_add_f32 v[84:85], v[84:85], v[124:125]
    v_pk_add_f32 v[86:87], v[86:87], v[126:127]
    v_pk_add_f32 v[88:89], v[88:89], v[128:129]
    v_pk_add_f32 v[90:91], v[90:91], v[130:131]
TCE_5:
ST0_16:
    s_cbranch_execz F_DE
    v_cndmask_b32 v72, v85, v86, s[60:61]
    v_cndmask_b32 v73, v84, v85, s[62:63]
    v_cndmask_b32 v74, v84, v85, s[60:61]
    v_cndmask_b32 v75, v86, v87, s[62:63]
    v_cvt_pk_bf16_f32 v96, v72, v72
    v_cvt_pk_bf16_f32 v97, v85, v73
    v_cvt_pk_bf16_f32 v98, v74, v84
    v_cvt_pk_bf16_f32 v99, v84, v84
    v_cvt_pk_bf16_f32 v100, v87, v87
    v_cvt_pk_bf16_f32 v101, v87, v75
    v_cvt_pk_bf16_f32 v102, v86, v86
    v_cvt_pk_bf16_f32 v103, v86, v86
    v_cndmask_b32 v76, v89, v90, s[60:61]
    v_cndmask_b32 v77, v88, v89, s[62:63]
    v_cndmask_b32 v78, v88, v89, s[60:61]
    v_cndmask_b32 v79, v90, v91, s[62:63]
    v_cvt_pk_bf16_f32 v104, v76, v76
    v_cvt_pk_bf16_f32 v105, v89, v77
    v_cvt_pk_bf16_f32 v106, v78, v88
    v_cvt_pk_bf16_f32 v107, v88, v88
    v_cvt_pk_bf16_f32 v108, v91, v91
    v_cvt_pk_bf16_f32 v109, v91, v79
    v_cvt_pk_bf16_f32 v110, v90, v90
    v_cvt_pk_bf16_f32 v111, v90, v90
    s_waitcnt vmcnt(0)
    v_mov_b32 v162, 2
    s_mov_b32 s16, 400000
    s_waitcnt lgkmcnt(0)
    ds_write_b32 v161, v162
F_HS2b:
    ds_read_b128 v[164:167], v160 offset:32
    ds_read_b128 v[64:67], v160 offset:96
    ds_read_b128 v[68:71], v160 offset:112
    s_waitcnt lgkmcnt(0)
    v_min3_u32 v164, v164, v64, v65
    v_min3_u32 v164, v164, v66, v67
    v_min3_u32 v164, v164, v68, v69
    v_min3_u32 v164, v164, v70, v71
    v_min3_u32 v164, v164, v165, v166
    v_min_u32 v164, v164, v167
    s_nop 0
    v_readfirstlane_b32 s66, v164
    s_sub_u32 s16, s16, 1
    s_cselect_b32 s66, 2, s66
    s_cmp_lt_u32 s66, 2
    s_cbranch_scc1 F_HS2b
    ds_write_b128 v34, v[96:99] offset:0
    ds_write_b128 v34, v[104:107] offset:256
    s_mov_b32 exec_lo, 0
    ds_write_b128 v34, v[100:103] offset:512
    ds_write_b128 v34, v[108:111] offset:768
    s_mov_b32 exec_lo, -1
F_NHY:
    ds_write_b128 v24, v[40:43]
    ds_write_b32 v25, v40
    s_cmp_lg_u32 s64, 0
    s_cbranch_scc1 F_HA
    v_mov_b32 v163, 1
    s_mov_b64 exec, 1
    buffer_atomic_add v163, off, s[36:39], s17 offset:0 sc0 sc1
    s_mov_b64 exec, -1
    s_and_b32 s18, s21, 0xfffff000
    v_lshlrev_b32 v162, 7, v0
    s_waitcnt vmcnt(0)
    v_readfirstlane_b32 s66, v163
    s_cmp_lg_u32 s66, 31
    s_cbranch_scc1 F_HA
    s_mov_b32 exec_hi, 0
    buffer_store_dword v162, v162, s[44:47], s18 offen offset:0 sc1
    s_mov_b32 exec_hi, -1
F_HA:
    s_mov_b64 exec, 0
    s_cmp_eq_u32 s64, 0
    s_cbranch_scc1 TCD_0
    s_cmp_eq_u32 s64, 1
    s_cbranch_scc1 TCD_1
    s_cmp_eq_u32 s64, 2
    s_cbranch_scc1 TCD_2
    s_branch TCD_3
F_HT:
    s_mov_b64 exec, -1
    s_mov_b32 s18, 200000
F_HU:
    buffer_load_dword v163, off, s[44:47], s21 offset:0 sc1
    s_waitcnt vmcnt(0)
    v_cmp_eq_u32 vcc, -1, v163
    s_cmp_eq_u64 vcc, 0
    s_cbranch_scc1 F_HUK
    s_sub_u32 s18, s18, 1
    s_cbranch_scc0 F_HU
F_HUK:
    buffer_load_dword v133, v23, s[44:47], s14 offen sc1
    buffer_load_dwordx4 v[134:137], v22, s[44:47], s13 offen offset:0 sc1
    buffer_load_dwordx4 v[138:141], v22, s[44:47], s13 offen offset:128 sc1
    s_mov_b32 s60, 0x05040100
    s_mov_b32 s61, 0x07060302
    s_waitcnt vmcnt(0)
    v_mov_b32_dpp v133, v141 wave_shr:1 row_mask:0xf bank_mask:0xf
    v_perm_b32 v144, v134, v133, s60
    v_perm_b32 v145, v136, v135, s60
    v_perm_b32 v146, v138, v137, s60
    v_perm_b32 v147, v140, v139, s60
    ds_write_b128 v21, v[144:147] offset:8512
    ds_write2_b32 v30, v144, v145 offset1:1
    ds_write2_b32 v30, v146, v147 offset0:2 offset1:3
    v_perm_b32 v148, v135, v134, s60
    v_perm_b32 v149, v137, v136, s60
    v_perm_b32 v150, v139, v138, s60
    v_perm_b32 v151, v141, v140, s60
    ds_write_b128 v21, v[148:151] offset:12768
    ds_write2_b32 v31, v148, v149 offset1:1
    ds_write2_b32 v31, v150, v151 offset0:2 offset1:3
    v_perm_b32 v152, v134, v133, s61
    v_perm_b32 v153, v136, v135, s61
    v_perm_b32 v154, v138, v137, s61
    v_perm_b32 v155, v140, v139, s61
    ds_write_b128 v21, v[152:155] offset:25536
    ds_write2_b32 v32, v152, v153 offset1:1
    ds_write2_b32 v32, v154, v155 offset0:2 offset1:3
    v_perm_b32 v156, v135, v134, s61
    v_perm_b32 v157, v137, v136, s61
    v_perm_b32 v158, v139, v138, s61
    v_perm_b32 v159, v141, v140, s61
    ds_write_b128 v21, v[156:159] offset:29792
    ds_write2_b32 v33, v156, v157 offset1:1
    ds_write2_b32 v33, v158, v159 offset0:2 offset1:3
    v_mov_b32 v162, 3
    s_mov_b32 s16, 400000
    s_waitcnt lgkmcnt(0)
    ds_write_b32 v161, v162
F_HS3:
    ds_read_b128 v[164:167], v160 offset:32
    s_waitcnt lgkmcnt(0)
    v_min3_u32 v164, v164, v165, v166
    v_min_u32 v164, v164, v167
    s_nop 0
    v_readfirstlane_b32 s66, v164
    s_sub_u32 s16, s16, 1
    s_cselect_b32 s66, 3, s66
    s_cmp_lt_u32 s66, 3
    s_cbranch_scc1 F_HS3
    s_setprio 1
    s_cmp_eq_u32 s10, 0
    s_cbranch_scc0 F_C81
    ds_read2_b64 v[128:131], v18 offset0:6 offset1:7
    ds_read_b128 v[132:135], v20 offset:3968
    ds_read_b128 v[136:139], v20 offset:2432
    ds_read_b128 v[140:143], v20 offset:1920
    s_waitcnt lgkmcnt(2)
    v_mfma_f32_32x32x16_bf16 v[112:127], v[128:131], v[132:135], 0
    s_nop 15
    s_nop 0
    ds_read2_b64 v[144:147], v18 offset0:70 offset1:71
    s_waitcnt lgkmcnt(2)
    v_mfma_f32_32x32x16_bf16 v[96:111], v[128:131], v[136:139], 0
    s_nop 15
    s_nop 0
    ds_read_b128 v[148:151], v20 offset:3456
    s_waitcnt lgkmcnt(2)
    v_mfma_f32_32x32x16_bf16 v[80:95], v[128:131], v[140:143], 0
    s_nop 15
    s_nop 0
    ds_read_b128 v[152:155], v20 offset:1408
    s_waitcnt lgkmcnt(1)
    v_mfma_f32_32x32x16_bf16 v[112:127], v[144:147], v[148:151], v[112:127]
    s_add_u32 m0, s15, 65536
    s_nop 0
    buffer_load_dwordx4 v26, s[56:59], s11 offen offset:0 lds
    s_nop 15
    s_nop 0
    ds_read2_b64 v[156:159], v19 offset0:70 offset1:71
    v_mfma_f32_32x32x16_bf16 v[96:111], v[144:147], v[140:143], v[96:111]
ST0_17:
    s_cbranch_execz F_DE
    s_nop 15
    s_nop 0
    ds_read2_b64 v[52:55], v18 offset0:134 offset1:135
    s_waitcnt lgkmcnt(2)
    v_mfma_f32_32x32x16_bf16 v[80:95], v[144:147], v[152:155], v[80:95]
    s_nop 15
    s_nop 0
    ds_read_b128 v[56:59], v20 offset:2944
    s_waitcnt lgkmcnt(2)
    v_mfma_f32_32x32x16_bf16 v[112:127], v[156:159], v[152:155], v[112:127]
    s_nop 15
    s_nop 0
    ds_read_b128 v[60:63], v20 offset:896
    s_waitcnt lgkmcnt(2)
    v_mfma_f32_32x32x16_bf16 v[96:111], v[52:55], v[152:155], v[96:111]
    buffer_load_dwordx4 v27, s[56:59], s11 offen offset:1024 lds
    s_nop 15
    s_nop 0
    ds_read2_b64 v[8:11], v19 offset0:134 offset1:135
    s_waitcnt lgkmcnt(2)
    v_mfma_f32_32x32x16_bf16 v[112:127], v[52:55], v[56:59], v[112:127]
    s_nop 15
    s_nop 0
    ds_read2_b64 v[12:15], v18 offset0:198 offset1:199
    s_waitcnt lgkmcnt(2)
    v_mfma_f32_32x32x16_bf16 v[80:95], v[52:55], v[60:63], v[80:95]
    s_nop 15
    s_nop 0
    s_waitcnt lgkmcnt(1)
    v_mfma_f32_32x32x16_bf16 v[112:127], v[8:11], v[60:63], v[112:127]
    s_nop 15
    s_nop 0
    ds_read_b128 v[132:135], v20 offset:384
    s_waitcnt lgkmcnt(1)
    v_mfma_f32_32x32x16_bf16 v[96:111], v[12:15], v[60:63], v[96:111]
    buffer_load_dwordx4 v28, s[56:59], s11 offen offset:2048 lds
    s_nop 15
    s_nop 0
    v_mfma_f32_32x32x16_bf16 v[112:127], v[12:15], v[136:139], v[112:127]
    s_nop 15
    s_nop 0
    ds_read2_b64 v[148:151], v19 offset0:198 offset1:199
    s_waitcnt lgkmcnt(1)
    v_mfma_f32_32x32x16_bf16 v[80:95], v[12:15], v[132:135], v[80:95]
    s_nop 15
    s_nop 0
    ds_read2_b64 v[144:147], v19 offset0:6 offset1:7
    v_mfma_f32_32x32x16_bf16 v[64:79], v[128:131], v[132:135], 0
    s_nop 15
    s_nop 0
    s_waitcnt lgkmcnt(1)
    v_mfma_f32_32x32x16_bf16 v[112:127], v[148:151], v[132:135], v[112:127]
    buffer_load_dwordx4 v29, s[56:59], s11 offen offset:3072 lds
    s_add_u32 s11, s11, 0x20000
    s_nop 15
    s_nop 0
    ds_read2_b64 v[156:159], v18 offset0:22 offset1:23
    s_waitcnt lgkmcnt(1)
    v_mfma_f32_32x32x16_bf16 v[96:111], v[144:147], v[132:135], v[96:111]
    s_nop 15
    s_nop 0
    ds_read_b128 v[152:155], v20 offset:3840
    v_mfma_f32_32x32x16_bf16 v[112:127], v[144:147], v[140:143], v[112:127]
    s_nop 15
    s_nop 0
    ds_read_b128 v[56:59], v20 offset:2304
    s_waitcnt lgkmcnt(1)
    v_mfma_f32_32x32x16_bf16 v[112:127], v[156:159], v[152:155], v[112:127]
    s_nop 15
    s_nop 0
    ds_read_b128 v[52:55], v20 offset:1792
    s_waitcnt lgkmcnt(1)
    v_mfma_f32_32x32x16_bf16 v[96:111], v[156:159], v[56:59], v[96:111]
    s_add_u32 m0, s15, 81920
    s_nop 0
    buffer_load_dwordx4 v26, s[56:59], s11 offen offset:0 lds
    s_nop 15
    s_nop 0
    ds_read2_b64 v[8:11], v18 offset0:86 offset1:87
    ds_read_b128 v[60:63], v20 offset:3328
    s_waitcnt lgkmcnt(2)
    v_mfma_f32_32x32x16_bf16 v[80:95], v[156:159], v[52:55], v[80:95]
    s_nop 15
    s_nop 0
    ds_read_b128 v[136:139], v20 offset:1280
    s_waitcnt lgkmcnt(1)
    v_mfma_f32_32x32x16_bf16 v[112:127], v[8:11], v[60:63], v[112:127]
    s_nop 15
    s_nop 0
    ds_read2_b64 v[12:15], v19 offset0:86 offset1:87
    v_mfma_f32_32x32x16_bf16 v[96:111], v[8:11], v[52:55], v[96:111]
    s_nop 15
    s_nop 0
    ds_read2_b64 v[128:131], v18 offset0:150 offset1:151
    s_waitcnt lgkmcnt(2)
    v_mfma_f32_32x32x16_bf16 v[80:95], v[8:11], v[136:139], v[80:95]
    buffer_load_dwordx4 v27, s[56:59], s11 offen offset:1024 lds
    s_nop 15
    s_nop 0
    ds_read_b128 v[148:151], v20 offset:2816
    s_waitcnt lgkmcnt(2)
    v_mfma_f32_32x32x16_bf16 v[112:127], v[12:15], v[136:139], v[112:127]
    s_nop 15
    s_nop 0
    ds_read_b128 v[132:135], v20 offset:768
    s_waitcnt lgkmcnt(2)
    v_mfma_f32_32x32x16_bf16 v[96:111], v[128:131], v[136:139], v[96:111]
    s_nop 15
    s_nop 0
    ds_read2_b64 v[140:143], v19 offset0:150 offset1:151
    s_waitcnt lgkmcnt(2)
    v_mfma_f32_32x32x16_bf16 v[112:127], v[128:131], v[148:151], v[112:127]
    s_nop 15
    s_nop 0
    ds_read2_b64 v[144:147], v18 offset0:214 offset1:215
    s_waitcnt lgkmcnt(2)
    v_mfma_f32_32x32x16_bf16 v[80:95], v[128:131], v[132:135], v[80:95]
    buffer_load_dwordx4 v28, s[56:59], s11 offen offset:2048 lds
    s_nop 15
    s_nop 0
    s_waitcnt lgkmcnt(1)
    v_mfma_f32_32x32x16_bf16 v[112:127], v[140:143], v[132:135], v[112:127]
    s_nop 15
    s_nop 0
    ds_read_b128 v[152:155], v20 offset:256
    s_waitcnt lgkmcnt(1)
    v_mfma_f32_32x32x16_bf16 v[96:111], v[144:147], v[132:135], v[96:111]
    s_nop 15
    s_nop 0
    v_mfma_f32_32x32x16_bf16 v[112:127], v[144:147], v[56:59], v[112:127]
    s_nop 15
    s_nop 0
    ds_read2_b64 v[60:63], v19 offset0:214 offset1:215
    s_waitcnt lgkmcnt(1)
    v_mfma_f32_32x32x16_bf16 v[80:95], v[144:147], v[152:155], v[80:95]
    buffer_load_dwordx4 v29, s[56:59], s11 offen offset:3072 lds
    s_add_u32 s11, s11, 0x20000
    s_nop 15
    s_nop 0
    ds_read2_b64 v[8:11], v19 offset0:22 offset1:23
    v_mfma_f32_32x32x16_bf16 v[64:79], v[156:159], v[152:155], v[64:79]
    s_nop 15
    s_nop 0
    s_waitcnt lgkmcnt(1)
    v_mfma_f32_32x32x16_bf16 v[112:127], v[60:63], v[152:155], v[112:127]
    s_nop 15
    s_nop 0
    ds_read2_b64 v[12:15], v18 offset0:38 offset1:39
    s_waitcnt lgkmcnt(1)
    v_mfma_f32_32x32x16_bf16 v[96:111], v[8:11], v[152:155], v[96:111]
    s_nop 15
    s_nop 0
    ds_read_b128 v[136:139], v20 offset:3712
    v_mfma_f32_32x32x16_bf16 v[112:127], v[8:11], v[52:55], v[112:127]
    s_add_u32 m0, s15, 98304
    s_nop 0
    buffer_load_dwordx4 v26, s[56:59], s11 offen offset:0 lds
    s_nop 15
    s_nop 0
    ds_read_b128 v[148:151], v20 offset:2176
    s_waitcnt lgkmcnt(1)
    v_mfma_f32_32x32x16_bf16 v[112:127], v[12:15], v[136:139], v[112:127]
    s_nop 15
    s_nop 0
    ds_read_b128 v[128:131], v20 offset:1664
    s_waitcnt lgkmcnt(1)
    v_mfma_f32_32x32x16_bf16 v[96:111], v[12:15], v[148:151], v[96:111]
    s_nop 15
    s_nop 0
    ds_read2_b64 v[140:143], v18 offset0:102 offset1:103
    ds_read_b128 v[132:135], v20 offset:3200
    s_waitcnt lgkmcnt(2)
    v_mfma_f32_32x32x16_bf16 v[80:95], v[12:15], v[128:131], v[80:95]
TCD_3:
ST0_18:
    s_cbranch_execz ST0_22
    s_nop 15
    s_nop 0
    ds_read_b128 v[56:59], v20 offset:1152
    s_waitcnt lgkmcnt(1)
    v_mfma_f32_32x32x16_bf16 v[112:127], v[140:143], v[132:135], v[112:127]
    buffer_load_dwordx4 v27, s[56:59], s11 offen offset:1024 lds
    s_nop 15
    s_nop 0
    ds_read2_b64 v[144:147], v19 offset0:102 offset1:103
    v_mfma_f32_32x32x16_bf16 v[96:111], v[140:143], v[128:131], v[96:111]
    s_nop 15
    s_nop 0
    ds_read2_b64 v[156:159], v18 offset0:166 offset1:167
    s_waitcnt lgkmcnt(2)
    v_mfma_f32_32x32x16_bf16 v[80:95], v[140:143], v[56:59], v[80:95]
    s_nop 15
    s_nop 0
    ds_read_b128 v[60:63], v20 offset:2688
    s_waitcnt lgkmcnt(2)
    v_mfma_f32_32x32x16_bf16 v[112:127], v[144:147], v[56:59], v[112:127]
    s_nop 15
    s_nop 0
    ds_read_b128 v[152:155], v20 offset:640
    s_waitcnt lgkmcnt(2)
    v_mfma_f32_32x32x16_bf16 v[96:111], v[156:159], v[56:59], v[96:111]
    buffer_load_dwordx4 v28, s[56:59], s11 offen offset:2048 lds
    s_nop 15
    s_nop 0
    ds_read2_b64 v[52:55], v19 offset0:166 offset1:167
    s_waitcnt lgkmcnt(2)
    v_mfma_f32_32x32x16_bf16 v[112:127], v[156:159], v[60:63], v[112:127]
    s_nop 15
    s_nop 0
    ds_read2_b64 v[8:11], v18 offset0:230 offset1:231
    s_waitcnt lgkmcnt(2)
    v_mfma_f32_32x32x16_bf16 v[80:95], v[156:159], v[152:155], v[80:95]
    s_nop 15
    s_nop 0
    s_waitcnt lgkmcnt(1)
    v_mfma_f32_32x32x16_bf16 v[112:127], v[52:55], v[152:155], v[112:127]
    s_nop 15
    s_nop 0
    ds_read_b128 v[136:139], v20 offset:128
    s_waitcnt lgkmcnt(1)
    v_mfma_f32_32x32x16_bf16 v[96:111], v[8:11], v[152:155], v[96:111]
    buffer_load_dwordx4 v29, s[56:59], s11 offen offset:3072 lds
    s_add_u32 s11, s11, 0x20000
    s_nop 15
    s_nop 0
    v_mfma_f32_32x32x16_bf16 v[112:127], v[8:11], v[148:151], v[112:127]
    s_nop 15
    s_nop 0
    ds_read2_b64 v[132:135], v19 offset0:230 offset1:231
    s_waitcnt lgkmcnt(1)
    v_mfma_f32_32x32x16_bf16 v[80:95], v[8:11], v[136:139], v[80:95]
    s_nop 15
    s_nop 0
    ds_read2_b64 v[140:143], v19 offset0:38 offset1:39
    v_mfma_f32_32x32x16_bf16 v[64:79], v[12:15], v[136:139], v[64:79]
    s_nop 15
    s_nop 0
    s_waitcnt lgkmcnt(1)
    v_mfma_f32_32x32x16_bf16 v[112:127], v[132:135], v[136:139], v[112:127]
    s_add_u32 m0, s15, 114688
    s_nop 0
    buffer_load_dwordx4 v26, s[56:59], s11 offen offset:0 lds
    s_nop 15
    s_nop 0
    ds_read2_b64 v[144:147], v18 offset0:54 offset1:55
    s_waitcnt lgkmcnt(1)
    v_mfma_f32_32x32x16_bf16 v[96:111], v[140:143], v[136:139], v[96:111]
    s_nop 15
    s_nop 0
    ds_read_b128 v[56:59], v20 offset:3584
    v_mfma_f32_32x32x16_bf16 v[112:127], v[140:143], v[128:131], v[112:127]
    s_nop 15
    s_nop 0
    ds_read_b128 v[60:63], v20 offset:2048
    s_waitcnt lgkmcnt(1)
    v_mfma_f32_32x32x16_bf16 v[112:127], v[144:147], v[56:59], v[112:127]
    s_nop 15
    s_nop 0
    ds_read_b128 v[156:159], v20 offset:1536
    s_waitcnt lgkmcnt(1)
    v_mfma_f32_32x32x16_bf16 v[96:111], v[144:147], v[60:63], v[96:111]
    buffer_load_dwordx4 v27, s[56:59], s11 offen offset:1024 lds
    s_nop 15
    s_nop 0
    ds_read2_b64 v[52:55], v18 offset0:118 offset1:119
    ds_read_b128 v[152:155], v20 offset:3072
    s_waitcnt lgkmcnt(2)
    v_mfma_f32_32x32x16_bf16 v[80:95], v[144:147], v[156:159], v[80:95]
    s_nop 15
    s_nop 0
    ds_read_b128 v[148:151], v20 offset:1024
    s_waitcnt lgkmcnt(1)
    v_mfma_f32_32x32x16_bf16 v[112:127], v[52:55], v[152:155], v[112:127]
    s_nop 15
    s_nop 0
    ds_read2_b64 v[8:11], v19 offset0:118 offset1:119
    v_mfma_f32_32x32x16_bf16 v[96:111], v[52:55], v[156:159], v[96:111]
    s_nop 15
    s_nop 0
    ds_read2_b64 v[12:15], v18 offset0:182 offset1:183
    s_waitcnt lgkmcnt(2)
    v_mfma_f32_32x32x16_bf16 v[80:95], v[52:55], v[148:151], v[80:95]
    buffer_load_dwordx4 v28, s[56:59], s11 offen offset:2048 lds
    s_nop 15
    s_nop 0
    ds_read_b128 v[132:135], v20 offset:2560
    s_waitcnt lgkmcnt(2)
    v_mfma_f32_32x32x16_bf16 v[112:127], v[8:11], v[148:151], v[112:127]
    s_nop 15
    s_nop 0
    ds_read_b128 v[136:139], v20 offset:512
    s_waitcnt lgkmcnt(2)
    v_mfma_f32_32x32x16_bf16 v[96:111], v[12:15], v[148:151], v[96:111]
    s_nop 15
    s_nop 0
    ds_read2_b64 v[128:131], v19 offset0:182 offset1:183
    s_waitcnt lgkmcnt(2)
    v_mfma_f32_32x32x16_bf16 v[112:127], v[12:15], v[132:135], v[112:127]
    s_nop 15
    s_nop 0
    ds_read2_b64 v[140:143], v18 offset0:246 offset1:247
    s_waitcnt lgkmcnt(2)
    v_mfma_f32_32x32x16_bf16 v[80:95], v[12:15], v[136:139], v[80:95]
    buffer_load_dwordx4 v29, s[56:59], s11 offen offset:3072 lds
    s_add_u32 s11, s11, 0x20000
    s_nop 15
    s_nop 0
    s_waitcnt lgkmcnt(1)
    v_mfma_f32_32x32x16_bf16 v[112:127], v[128:131], v[136:139], v[112:127]
    s_nop 15
    s_nop 0
    ds_read_b128 v[56:59], v20 offset:0
    s_waitcnt lgkmcnt(1)
    v_mfma_f32_32x32x16_bf16 v[96:111], v[140:143], v[136:139], v[96:111]
    s_nop 15
    s_nop 0
    v_mfma_f32_32x32x16_bf16 v[112:127], v[140:143], v[60:63], v[112:127]
    s_nop 15
    s_nop 0
    ds_read2_b64 v[152:155], v19 offset0:246 offset1:247
    s_waitcnt lgkmcnt(1)
    v_mfma_f32_32x32x16_bf16 v[80:95], v[140:143], v[56:59], v[80:95]
    s_nop 15
    s_nop 0
    ds_read2_b64 v[52:55], v19 offset0:54 offset1:55
    v_mfma_f32_32x32x16_bf16 v[64:79], v[144:147], v[56:59], v[64:79]
    s_nop 15
    s_nop 0
    s_waitcnt lgkmcnt(1)
    v_mfma_f32_32x32x16_bf16 v[112:127], v[152:155], v[56:59], v[112:127]
    s_nop 15
    s_nop 0
    s_waitcnt lgkmcnt(0)
    v_mfma_f32_32x32x16_bf16 v[96:111], v[52:55], v[56:59], v[96:111]
    s_nop 15
    s_nop 0
    v_mfma_f32_32x32x16_bf16 v[112:127], v[52:55], v[156:159], v[112:127]
    s_branch F_C8X
F_C81:
    ds_read2_b64 v[128:131], v18 offset0:6 offset1:7
    ds_read_b128 v[132:135], v20 offset:3456
    ds_read_b128 v[136:139], v20 offset:2944
    ds_read2_b64 v[140:143], v18 offset0:70 offset1:71
    s_waitcnt lgkmcnt(2)
    v_mfma_f32_32x32x16_bf16 v[112:127], v[128:131], v[132:135], 0
    s_nop 15
    s_nop 0
    ds_read_b128 v[144:147], v20 offset:2432
    s_waitcnt lgkmcnt(2)
    v_mfma_f32_32x32x16_bf16 v[96:111], v[128:131], v[136:139], 0
    s_nop 15
    s_nop 0
    ds_read2_b64 v[148:151], v18 offset0:134 offset1:135
    s_waitcnt lgkmcnt(2)
    v_mfma_f32_32x32x16_bf16 v[112:127], v[140:143], v[136:139], v[112:127]
TCD_2:
ST0_19:
    s_cbranch_execz ST0_10
    s_nop 15
    s_nop 0
    ds_read_b128 v[152:155], v20 offset:1920
    s_waitcnt lgkmcnt(2)
    v_mfma_f32_32x32x16_bf16 v[96:111], v[140:143], v[144:147], v[96:111]
    s_add_u32 m0, s15, 65536
    s_nop 0
    buffer_load_dwordx4 v26, s[56:59], s11 offen offset:0 lds
    s_nop 15
    s_nop 0
    ds_read2_b64 v[156:159], v18 offset0:198 offset1:199
    s_waitcnt lgkmcnt(2)
    v_mfma_f32_32x32x16_bf16 v[112:127], v[148:151], v[144:147], v[112:127]
    s_nop 15
    s_nop 0
    ds_read_b128 v[52:55], v20 offset:1408
    s_waitcnt lgkmcnt(2)
    v_mfma_f32_32x32x16_bf16 v[96:111], v[148:151], v[152:155], v[96:111]
    s_nop 15
    s_nop 0
    s_waitcnt lgkmcnt(1)
    v_mfma_f32_32x32x16_bf16 v[112:127], v[156:159], v[152:155], v[112:127]
    s_nop 15
    s_nop 0
    ds_read2_b64 v[56:59], v19 offset0:6 offset1:7
    s_waitcnt lgkmcnt(1)
    v_mfma_f32_32x32x16_bf16 v[96:111], v[156:159], v[52:55], v[96:111]
    buffer_load_dwordx4 v27, s[56:59], s11 offen offset:1024 lds
    s_nop 15
    s_nop 0
    ds_read_b128 v[60:63], v20 offset:896
    v_mfma_f32_32x32x16_bf16 v[80:95], v[128:131], v[52:55], 0
    s_nop 15
    s_nop 0
    s_waitcnt lgkmcnt(1)
    v_mfma_f32_32x32x16_bf16 v[112:127], v[56:59], v[52:55], v[112:127]
    s_nop 15
    s_nop 0
    s_waitcnt lgkmcnt(0)
    v_mfma_f32_32x32x16_bf16 v[96:111], v[56:59], v[60:63], v[96:111]
    s_nop 15
    s_nop 0
    ds_read2_b64 v[8:11], v19 offset0:70 offset1:71
    v_mfma_f32_32x32x16_bf16 v[64:79], v[128:131], v[60:63], 0
    buffer_load_dwordx4 v28, s[56:59], s11 offen offset:2048 lds
    s_nop 15
    s_nop 0
    ds_read_b128 v[12:15], v20 offset:384
    v_mfma_f32_32x32x16_bf16 v[80:95], v[140:143], v[60:63], v[80:95]
    s_nop 15
    s_nop 0
    s_waitcnt lgkmcnt(1)
    v_mfma_f32_32x32x16_bf16 v[112:127], v[8:11], v[60:63], v[112:127]
    s_nop 15
    s_nop 0
    s_waitcnt lgkmcnt(0)
    v_mfma_f32_32x32x16_bf16 v[96:111], v[8:11], v[12:15], v[96:111]
    s_nop 15
    s_nop 0
    ds_read2_b64 v[132:135], v19 offset0:134 offset1:135
    v_mfma_f32_32x32x16_bf16 v[64:79], v[140:143], v[12:15], v[64:79]
    buffer_load_dwordx4 v29, s[56:59], s11 offen offset:3072 lds
    s_add_u32 s11, s11, 0x20000
    s_nop 15
    s_nop 0
    ds_read2_b64 v[136:139], v18 offset0:22 offset1:23
    v_mfma_f32_32x32x16_bf16 v[80:95], v[148:151], v[12:15], v[80:95]
    s_nop 15
    s_nop 0
    ds_read_b128 v[144:147], v20 offset:3328
    s_waitcnt lgkmcnt(2)
    v_mfma_f32_32x32x16_bf16 v[112:127], v[132:135], v[12:15], v[112:127]
    s_nop 15
    s_nop 0
    ds_read_b128 v[152:155], v20 offset:2816
    s_waitcnt lgkmcnt(1)
    v_mfma_f32_32x32x16_bf16 v[112:127], v[136:139], v[144:147], v[112:127]
    s_nop 15
    s_nop 0
    ds_read2_b64 v[156:159], v18 offset0:86 offset1:87
    s_waitcnt lgkmcnt(1)
    v_mfma_f32_32x32x16_bf16 v[96:111], v[136:139], v[152:155], v[96:111]
    s_add_u32 m0, s15, 81920
    s_nop 0
    buffer_load_dwordx4 v26, s[56:59], s11 offen offset:0 lds
    s_nop 15
    s_nop 0
    ds_read_b128 v[52:55], v20 offset:2304
    s_waitcnt lgkmcnt(1)
    v_mfma_f32_32x32x16_bf16 v[112:127], v[156:159], v[152:155], v[112:127]
    s_nop 15
    s_nop 0
    ds_read2_b64 v[56:59], v18 offset0:150 offset1:151
    s_waitcnt lgkmcnt(1)
    v_mfma_f32_32x32x16_bf16 v[96:111], v[156:159], v[52:55], v[96:111]
    s_nop 15
    s_nop 0
    ds_read_b128 v[128:131], v20 offset:1792
    s_waitcnt lgkmcnt(1)
    v_mfma_f32_32x32x16_bf16 v[112:127], v[56:59], v[52:55], v[112:127]
    s_nop 15
    s_nop 0
    ds_read2_b64 v[60:63], v18 offset0:214 offset1:215
    s_waitcnt lgkmcnt(1)
    v_mfma_f32_32x32x16_bf16 v[96:111], v[56:59], v[128:131], v[96:111]
    buffer_load_dwordx4 v27, s[56:59], s11 offen offset:1024 lds
    s_nop 15
    s_nop 0
    ds_read_b128 v[8:11], v20 offset:1280
    s_waitcnt lgkmcnt(1)
    v_mfma_f32_32x32x16_bf16 v[112:127], v[60:63], v[128:131], v[112:127]
    s_nop 15
    s_nop 0
    ds_read2_b64 v[140:143], v19 offset0:22 offset1:23
    s_waitcnt lgkmcnt(1)
    v_mfma_f32_32x32x16_bf16 v[96:111], v[60:63], v[8:11], v[96:111]
    s_nop 15
    s_nop 0
    ds_read_b128 v[148:151], v20 offset:768
    v_mfma_f32_32x32x16_bf16 v[80:95], v[136:139], v[8:11], v[80:95]
    s_nop 15
    s_nop 0
    s_waitcnt lgkmcnt(1)
    v_mfma_f32_32x32x16_bf16 v[112:127], v[140:143], v[8:11], v[112:127]
    buffer_load_dwordx4 v28, s[56:59], s11 offen offset:2048 lds
    s_nop 15
    s_nop 0
    s_waitcnt lgkmcnt(0)
    v_mfma_f32_32x32x16_bf16 v[96:111], v[140:143], v[148:151], v[96:111]
    s_nop 15
    s_nop 0
    ds_read2_b64 v[132:135], v19 offset0:86 offset1:87
    v_mfma_f32_32x32x16_bf16 v[64:79], v[136:139], v[148:151], v[64:79]
    s_nop 15
    s_nop 0
    ds_read_b128 v[12:15], v20 offset:256
    v_mfma_f32_32x32x16_bf16 v[80:95], v[156:159], v[148:151], v[80:95]
    s_nop 15
    s_nop 0
    s_waitcnt lgkmcnt(1)
    v_mfma_f32_32x32x16_bf16 v[112:127], v[132:135], v[148:151], v[112:127]
    buffer_load_dwordx4 v29, s[56:59], s11 offen offset:3072 lds
    s_add_u32 s11, s11, 0x20000
    s_nop 15
    s_nop 0
    s_waitcnt lgkmcnt(0)
    v_mfma_f32_32x32x16_bf16 v[96:111], v[132:135], v[12:15], v[96:111]
    s_nop 15
    s_nop 0
    ds_read2_b64 v[144:147], v19 offset0:150 offset1:151
    v_mfma_f32_32x32x16_bf16 v[64:79], v[156:159], v[12:15], v[64:79]
    s_nop 15
    s_nop 0
    ds_read2_b64 v[152:155], v18 offset0:38 offset1:39
    v_mfma_f32_32x32x16_bf16 v[80:95], v[56:59], v[12:15], v[80:95]
    s_nop 15
    s_nop 0
    ds_read_b128 v[52:55], v20 offset:3200
    s_waitcnt lgkmcnt(2)
    v_mfma_f32_32x32x16_bf16 v[112:127], v[144:147], v[12:15], v[112:127]
    s_add_u32 m0, s15, 98304
    s_nop 0
    buffer_load_dwordx4 v26, s[56:59], s11 offen offset:0 lds
    s_nop 15
    s_nop 0
    ds_read_b128 v[128:131], v20 offset:2688
    s_waitcnt lgkmcnt(1)
    v_mfma_f32_32x32x16_bf16 v[112:127], v[152:155], v[52:55], v[112:127]
    s_nop 15
    s_nop 0
    ds_read2_b64 v[60:63], v18 offset0:102 offset1:103
    s_waitcnt lgkmcnt(1)
    v_mfma_f32_32x32x16_bf16 v[96:111], v[152:155], v[128:131], v[96:111]
    s_nop 15
    s_nop 0
    ds_read_b128 v[8:11], v20 offset:2176
    s_waitcnt lgkmcnt(1)
    v_mfma_f32_32x32x16_bf16 v[112:127], v[60:63], v[128:131], v[112:127]
TCD_1:
ST0_20:
    s_cbranch_execz F_HT
    s_nop 15
    s_nop 0
    ds_read2_b64 v[140:143], v18 offset0:166 offset1:167
    s_waitcnt lgkmcnt(1)
    v_mfma_f32_32x32x16_bf16 v[96:111], v[60:63], v[8:11], v[96:111]
    buffer_load_dwordx4 v27, s[56:59], s11 offen offset:1024 lds
    s_nop 15
    s_nop 0
    ds_read_b128 v[136:139], v20 offset:1664
    s_waitcnt lgkmcnt(1)
    v_mfma_f32_32x32x16_bf16 v[112:127], v[140:143], v[8:11], v[112:127]
    s_nop 15
    s_nop 0
    ds_read2_b64 v[148:151], v18 offset0:230 offset1:231
    s_waitcnt lgkmcnt(1)
    v_mfma_f32_32x32x16_bf16 v[96:111], v[140:143], v[136:139], v[96:111]
    s_nop 15
    s_nop 0
    ds_read_b128 v[132:135], v20 offset:1152
    s_waitcnt lgkmcnt(1)
    v_mfma_f32_32x32x16_bf16 v[112:127], v[148:151], v[136:139], v[112:127]
    s_nop 15
    s_nop 0
    ds_read2_b64 v[156:159], v19 offset0:38 offset1:39
    s_waitcnt lgkmcnt(1)
    v_mfma_f32_32x32x16_bf16 v[96:111], v[148:151], v[132:135], v[96:111]
    buffer_load_dwordx4 v28, s[56:59], s11 offen offset:2048 lds
    s_nop 15
    s_nop 0
    ds_read_b128 v[56:59], v20 offset:640
    v_mfma_f32_32x32x16_bf16 v[80:95], v[152:155], v[132:135], v[80:95]
    s_nop 15
    s_nop 0
    s_waitcnt lgkmcnt(1)
    v_mfma_f32_32x32x16_bf16 v[112:127], v[156:159], v[132:135], v[112:127]
    s_nop 15
    s_nop 0
    s_waitcnt lgkmcnt(0)
    v_mfma_f32_32x32x16_bf16 v[96:111], v[156:159], v[56:59], v[96:111]
    s_nop 15
    s_nop 0
    ds_read2_b64 v[144:147], v19 offset0:102 offset1:103
    v_mfma_f32_32x32x16_bf16 v[64:79], v[152:155], v[56:59], v[64:79]
    buffer_load_dwordx4 v29, s[56:59], s11 offen offset:3072 lds
    s_add_u32 s11, s11, 0x20000
    s_nop 15
    s_nop 0
    ds_read_b128 v[12:15], v20 offset:128
    v_mfma_f32_32x32x16_bf16 v[80:95], v[60:63], v[56:59], v[80:95]
    s_nop 15
    s_nop 0
    s_waitcnt lgkmcnt(1)
    v_mfma_f32_32x32x16_bf16 v[112:127], v[144:147], v[56:59], v[112:127]
    s_nop 15
    s_nop 0
    s_waitcnt lgkmcnt(0)
    v_mfma_f32_32x32x16_bf16 v[96:111], v[144:147], v[12:15], v[96:111]
    s_nop 15
    s_nop 0
    ds_read2_b64 v[52:55], v19 offset0:166 offset1:167
    v_mfma_f32_32x32x16_bf16 v[64:79], v[60:63], v[12:15], v[64:79]
    s_add_u32 m0, s15, 114688
    s_nop 0
    buffer_load_dwordx4 v26, s[56:59], s11 offen offset:0 lds
    s_nop 15
    s_nop 0
    ds_read2_b64 v[128:131], v18 offset0:54 offset1:55
    v_mfma_f32_32x32x16_bf16 v[80:95], v[140:143], v[12:15], v[80:95]
    s_nop 15
    s_nop 0
    ds_read_b128 v[8:11], v20 offset:3072
    s_waitcnt lgkmcnt(2)
    v_mfma_f32_32x32x16_bf16 v[112:127], v[52:55], v[12:15], v[112:127]
    s_nop 15
    s_nop 0
    ds_read_b128 v[136:139], v20 offset:2560
    s_waitcnt lgkmcnt(1)
    v_mfma_f32_32x32x16_bf16 v[112:127], v[128:131], v[8:11], v[112:127]
    s_nop 15
    s_nop 0
    ds_read2_b64 v[148:151], v18 offset0:118 offset1:119
    s_waitcnt lgkmcnt(1)
    v_mfma_f32_32x32x16_bf16 v[96:111], v[128:131], v[136:139], v[96:111]
    buffer_load_dwordx4 v27, s[56:59], s11 offen offset:1024 lds
    s_nop 15
    s_nop 0
    ds_read_b128 v[132:135], v20 offset:2048
    s_waitcnt lgkmcnt(1)
    v_mfma_f32_32x32x16_bf16 v[112:127], v[148:151], v[136:139], v[112:127]
    s_nop 15
    s_nop 0
    ds_read2_b64 v[156:159], v18 offset0:182 offset1:183
    s_waitcnt lgkmcnt(1)
    v_mfma_f32_32x32x16_bf16 v[96:111], v[148:151], v[132:135], v[96:111]
    s_nop 15
    s_nop 0
    ds_read_b128 v[152:155], v20 offset:1536
    s_waitcnt lgkmcnt(1)
    v_mfma_f32_32x32x16_bf16 v[112:127], v[156:159], v[132:135], v[112:127]
    s_nop 15
    s_nop 0
    ds_read2_b64 v[56:59], v18 offset0:246 offset1:247
    s_waitcnt lgkmcnt(1)
    v_mfma_f32_32x32x16_bf16 v[96:111], v[156:159], v[152:155], v[96:111]
    buffer_load_dwordx4 v28, s[56:59], s11 offen offset:2048 lds
    s_nop 15
    s_nop 0
    ds_read_b128 v[144:147], v20 offset:1024
    s_waitcnt lgkmcnt(1)
    v_mfma_f32_32x32x16_bf16 v[112:127], v[56:59], v[152:155], v[112:127]
    s_nop 15
    s_nop 0
    ds_read2_b64 v[60:63], v19 offset0:54 offset1:55
    s_waitcnt lgkmcnt(1)
    v_mfma_f32_32x32x16_bf16 v[96:111], v[56:59], v[144:147], v[96:111]
    s_nop 15
    s_nop 0
    ds_read_b128 v[140:143], v20 offset:512
    v_mfma_f32_32x32x16_bf16 v[80:95], v[128:131], v[144:147], v[80:95]
    s_nop 15
    s_nop 0
    s_waitcnt lgkmcnt(1)
    v_mfma_f32_32x32x16_bf16 v[112:127], v[60:63], v[144:147], v[112:127]
    buffer_load_dwordx4 v29, s[56:59], s11 offen offset:3072 lds
    s_add_u32 s11, s11, 0x20000
    s_nop 15
    s_nop 0
    s_waitcnt lgkmcnt(0)
    v_mfma_f32_32x32x16_bf16 v[96:111], v[60:63], v[140:143], v[96:111]
    s_nop 15
    s_nop 0
    ds_read2_b64 v[52:55], v19 offset0:118 offset1:119
    v_mfma_f32_32x32x16_bf16 v[64:79], v[128:131], v[140:143], v[64:79]
    s_nop 15
    s_nop 0
    ds_read_b128 v[12:15], v20 offset:0
    v_mfma_f32_32x32x16_bf16 v[80:95], v[148:151], v[140:143], v[80:95]
    s_nop 15
    s_nop 0
    s_waitcnt lgkmcnt(1)
    v_mfma_f32_32x32x16_bf16 v[112:127], v[52:55], v[140:143], v[112:127]
    s_nop 15
    s_nop 0
    s_waitcnt lgkmcnt(0)
    v_mfma_f32_32x32x16_bf16 v[96:111], v[52:55], v[12:15], v[96:111]
    s_nop 15
    s_nop 0
    ds_read2_b64 v[8:11], v19 offset0:182 offset1:183
    v_mfma_f32_32x32x16_bf16 v[64:79], v[148:151], v[12:15], v[64:79]
    s_nop 15
    s_nop 0
    v_mfma_f32_32x32x16_bf16 v[80:95], v[156:159], v[12:15], v[80:95]
    s_nop 15
    s_nop 0
    s_waitcnt lgkmcnt(0)
    v_mfma_f32_32x32x16_bf16 v[112:127], v[8:11], v[12:15], v[112:127]
F_C8X:
    v_mov_b32 v162, 4
    s_mov_b32 s16, 400000
    s_waitcnt lgkmcnt(0)
    ds_write_b32 v161, v162
F_HS4:
    ds_read_b128 v[164:167], v160 offset:32
    s_waitcnt lgkmcnt(0)
    v_min3_u32 v164, v164, v165, v166
    v_min_u32 v164, v164, v167
    s_nop 0
    v_readfirstlane_b32 s66, v164
    s_sub_u32 s16, s16, 1
    s_cselect_b32 s66, 4, s66
    s_cmp_lt_u32 s66, 4
    s_cbranch_scc1 F_HS4
    ds_write_b128 v44, v[64:67] offset:0
    ds_write_b128 v44, v[68:71] offset:8192
    ds_write_b128 v44, v[72:75] offset:16384
    ds_write_b128 v44, v[76:79] offset:24576
    ds_write_b128 v50, v[80:83] offset:1024
    ds_write_b128 v50, v[84:87] offset:9216
TCD_0:
ST0_21:
    s_cbranch_execz F_HT
    ds_write_b128 v50, v[88:91] offset:17408
    ds_write_b128 v50, v[92:95] offset:25600
    ds_write_b128 v44, v[96:99] offset:2048
    ds_write_b128 v44, v[100:103] offset:10240
    ds_write_b128 v44, v[104:107] offset:18432
    ds_write_b128 v44, v[108:111] offset:26624
    ds_write_b128 v50, v[112:115] offset:3072
    ds_write_b128 v50, v[116:119] offset:11264
    ds_write_b128 v50, v[120:123] offset:19456
    ds_write_b128 v50, v[124:127] offset:27648
    s_cmp_eq_u32 s64, 1
    s_cselect_b32 s62, 0xfffffffa, -1
    s_cmp_eq_u32 s64, 0
    s_cselect_b32 s60, 0xfffffffa, -1
    s_cselect_b32 s61, 0xffffffaa, -1
    s_and_b32 s62, s62, s61
    s_lshl_b32 s13, s9, 12
    s_add_u32 s14, s14, s13
    s_lshl_b32 s13, s10, 7
    s_add_u32 s14, s14, s13
    v_mov_b32 v162, 5
    s_mov_b32 s16, 400000
    s_waitcnt lgkmcnt(0)
    ds_write_b32 v161, v162
F_HS5:
    ds_read_b128 v[164:167], v160 offset:32
    s_waitcnt lgkmcnt(0)
    v_min3_u32 v164, v164, v165, v166
    v_min_u32 v164, v164, v167
    s_nop 0
    v_readfirstlane_b32 s66, v164
    s_sub_u32 s16, s16, 1
    s_cselect_b32 s66, 5, s66
    s_cmp_lt_u32 s66, 5
    s_cbranch_scc1 F_HS5
    ds_read_b128 v[64:67], v45 offset:0
    ds_read_b128 v[80:83], v45 offset:32768
    ds_read_b128 v[68:71], v45 offset:1024
    ds_read_b128 v[84:87], v45 offset:33792
    ds_read_b128 v[72:75], v45 offset:8176
    ds_read_b128 v[88:91], v45 offset:40944
    ds_read_b128 v[76:79], v45 offset:9200
    ds_read_b128 v[92:95], v45 offset:41968
    ds_read_b128 v[96:99], v45 offset:16352
    ds_read_b128 v[112:115], v45 offset:49120
    ds_read_b128 v[100:103], v45 offset:17376
    ds_read_b128 v[116:119], v45 offset:50144
    ds_read_b128 v[104:107], v45 offset:24528
    ds_read_b128 v[120:123], v45 offset:57296
    ds_read_b128 v[108:111], v45 offset:25552
    ds_read_b128 v[124:127], v45 offset:58320
    v_mov_b32 v162, 6
    s_waitcnt vmcnt(0) lgkmcnt(0)
    ds_write_b32 v161, v162
    v_add_f32 v68, v68, v76
    v_add_f32 v69, v69, v77
    v_add_f32 v84, v84, v92
    v_add_f32 v85, v85, v93
    v_add_f32 v70, v70, v78
    v_add_f32 v71, v71, v79
    v_add_f32 v86, v86, v94
    v_add_f32 v87, v87, v95
    v_add_f32 v68, v68, v100
    v_add_f32 v69, v69, v101
    v_add_f32 v84, v84, v116
    v_add_f32 v85, v85, v117
    v_add_f32 v70, v70, v102
    v_add_f32 v71, v71, v103
    v_add_f32 v86, v86, v118
    v_add_f32 v87, v87, v119
    v_add_f32 v68, v68, v108
    v_add_f32 v69, v69, v109
    v_add_f32 v84, v84, v124
    v_add_f32 v85, v85, v125
    v_add_f32 v70, v70, v110
    v_add_f32 v71, v71, v111
    v_add_f32 v86, v86, v126
    v_add_f32 v87, v87, v127
    s_mov_b32 exec_lo, s60
    v_add_f32 v64, v64, v72
    v_add_f32 v65, v65, v73
    v_add_f32 v80, v80, v88
    v_add_f32 v81, v81, v89
    v_add_f32 v66, v66, v74
    v_add_f32 v67, v67, v75
    v_add_f32 v82, v82, v90
    v_add_f32 v83, v83, v91
    s_mov_b32 exec_lo, s61
    v_add_f32 v64, v64, v96
    v_add_f32 v65, v65, v97
    v_add_f32 v80, v80, v112
    v_add_f32 v81, v81, v113
    v_add_f32 v66, v66, v98
    v_add_f32 v67, v67, v99
    v_add_f32 v82, v82, v114
    v_add_f32 v83, v83, v115
    s_mov_b32 exec_lo, s62
    v_add_f32 v64, v64, v104
    v_add_f32 v65, v65, v105
    v_add_f32 v80, v80, v120
    v_add_f32 v81, v81, v121
    v_add_f32 v66, v66, v106
    v_add_f32 v67, v67, v107
    v_add_f32 v82, v82, v122
    v_add_f32 v83, v83, v123
    s_mov_b32 exec_lo, -1
    v_cvt_pk_bf16_f32 v64, v64, v80
    v_cvt_pk_bf16_f32 v65, v65, v81
    v_cvt_pk_bf16_f32 v66, v66, v82
    v_cvt_pk_bf16_f32 v67, v67, v83
    v_cvt_pk_bf16_f32 v68, v68, v84
    v_cvt_pk_bf16_f32 v69, v69, v85
    v_cvt_pk_bf16_f32 v70, v70, v86
    v_cvt_pk_bf16_f32 v71, v71, v87
    buffer_store_dwordx4 v[64:67], v22, s[44:47], s14 offen offset:0 sc1
    buffer_store_dwordx4 v[68:71], v22, s[44:47], s14 offen offset:2048 sc1
    v_mov_b32 v162, 7
    s_cmp_eq_u32 s64, 0
    s_waitcnt vmcnt(0)
    s_cbranch_scc1 F_HY
    ds_write_b32 v161, v162
    s_endpgm
F_HY:
    v_mov_b32 v162, 7
    s_mov_b32 s16, 400000
    s_waitcnt lgkmcnt(0)
    ds_write_b32 v161, v162
F_HS7:
    ds_read_b128 v[164:167], v160 offset:32
    s_waitcnt lgkmcnt(0)
    v_min3_u32 v164, v164, v165, v166
    v_min_u32 v164, v164, v167
    s_nop 0
    v_readfirstlane_b32 s66, v164
    s_sub_u32 s16, s16, 1
    s_cselect_b32 s66, 7, s66
    s_cmp_lt_u32 s66, 7
    s_cbranch_scc1 F_HS7
    s_cmp_lg_u32 s64, 0
    s_cbranch_scc1 F_HZ
    v_mov_b32 v163, 1
    s_mov_b64 exec, 1
    buffer_atomic_add v163, off, s[36:39], s17 offset:8 sc0 sc1
    s_mov_b64 exec, -1
    s_and_b32 s18, s21, 0xfffff000
    v_lshlrev_b32 v162, 7, v0
    s_waitcnt vmcnt(0)
    v_readfirstlane_b32 s66, v163
    s_cmp_lg_u32 s66, 31
    s_cbranch_scc1 F_HZ
    s_mov_b32 exec_hi, 0
    buffer_store_dword v162, v162, s[44:47], s18 offen offset:8 sc1
    s_mov_b32 exec_hi, -1
F_HZ:
    s_lshl_b32 s13, s4, 18
    s_lshl_b32 s14, s5, 8
    s_add_u32 s13, s13, s14
    s_add_u32 s13, s13, 0x420000
    s_lshl_b32 s14, s5, 17
    s_lshl_b32 s15, s4, 7
    s_add_u32 s14, s14, s15
    s_add_u32 s14, s14, 1024
    s_mov_b32 s18, 200000
F_HW:
    buffer_load_dword v163, off, s[44:47], s21 offset:8 sc1
    s_waitcnt vmcnt(0)
    v_cmp_eq_u32 vcc, -1, v163
    s_cmp_eq_u64 vcc, 0
    s_cbranch_scc1 F_HWK
    s_sub_u32 s18, s18, 1
    s_cbranch_scc0 F_HW
F_HWK:
    buffer_load_dwordx4 v[64:67], v46, s[44:47], s13 offen offset:0 sc1
    buffer_load_dwordx4 v[80:83], v46, s[44:47], s13 offen offset:128 sc1
    s_add_u32 s13, s13, 8192
    buffer_load_dwordx4 v[68:71], v46, s[44:47], s13 offen offset:0 sc1
    buffer_load_dwordx4 v[84:87], v46, s[44:47], s13 offen offset:128 sc1
    s_add_u32 s13, s13, 8192
    buffer_load_dwordx4 v[72:75], v46, s[44:47], s13 offen offset:0 sc1
    buffer_load_dwordx4 v[88:91], v46, s[44:47], s13 offen offset:128 sc1
    s_add_u32 s13, s13, 8192
    buffer_load_dwordx4 v[76:79], v46, s[44:47], s13 offen offset:0 sc1
    buffer_load_dwordx4 v[92:95], v46, s[44:47], s13 offen offset:128 sc1
    s_waitcnt vmcnt(7)
    ds_write_b128 v47, v[64:67] offset:0
    s_waitcnt vmcnt(6)
    ds_write_b128 v47, v[80:83] offset:4096
    s_waitcnt vmcnt(5)
    ds_write_b128 v47, v[68:71] offset:1024
    s_waitcnt vmcnt(4)
    ds_write_b128 v47, v[84:87] offset:5120
    s_waitcnt vmcnt(3)
ST0_22:
    s_cbranch_execz F_HT
    ds_write_b128 v47, v[72:75] offset:2048
    s_waitcnt vmcnt(2)
    ds_write_b128 v47, v[88:91] offset:6144
    s_waitcnt vmcnt(1)
    ds_write_b128 v47, v[76:79] offset:3072
    s_waitcnt vmcnt(0)
    ds_write_b128 v47, v[92:95] offset:7168
    s_waitcnt lgkmcnt(0)
    ds_read_b128 v[64:67], v48 offset:0
    ds_read_b128 v[68:71], v48 offset:1024
    ds_read_b128 v[72:75], v48 offset:2048
    ds_read_b128 v[76:79], v48 offset:3072
    ds_read_b128 v[80:83], v48 offset:4096
    ds_read_b128 v[84:87], v48 offset:5120
    ds_read_b128 v[88:91], v48 offset:6144
    ds_read_b128 v[92:95], v48 offset:7168
    s_waitcnt lgkmcnt(4)
    v_swap_b32 v65, v68
    v_swap_b32 v66, v72
    v_swap_b32 v67, v76
    v_swap_b32 v70, v73
    v_swap_b32 v71, v77
    v_swap_b32 v75, v78
    buffer_store_dwordx4 v[64:67], v49, s[52:55], s14 offen offset:0 sc1
    buffer_store_dwordx4 v[68:71], v49, s[52:55], s14 offen offset:2048 sc1
    s_add_u32 s14, s14, 4096
    buffer_store_dwordx4 v[72:75], v49, s[52:55], s14 offen offset:0 sc1
    buffer_store_dwordx4 v[76:79], v49, s[52:55], s14 offen offset:2048 sc1
    s_add_u32 s14, s14, 28672
    s_waitcnt lgkmcnt(0)
    v_swap_b32 v81, v84
    v_swap_b32 v82, v88
    v_swap_b32 v83, v92
    v_swap_b32 v86, v89
    v_swap_b32 v87, v93
    v_swap_b32 v91, v94
    buffer_store_dwordx4 v[80:83], v49, s[52:55], s14 offen offset:0 sc1
    buffer_store_dwordx4 v[84:87], v49, s[52:55], s14 offen offset:2048 sc1
    s_add_u32 s14, s14, 4096
    buffer_store_dwordx4 v[88:91], v49, s[52:55], s14 offen offset:0 sc1
    buffer_store_dwordx4 v[92:95], v49, s[52:55], s14 offen offset:2048 sc1
    s_endpgm
F_SLOW:
    v_and_b32 v153, 0x7fff, v1
    v_and_b32 v154, 0x7fff, v2
    v_mov_b32 v152, 0xff800000
    s_mov_b32 s66, 0
    s_mov_b32 s67, 200000
F_S1:
    buffer_load_dwordx4 v[96:99], v153, s[44:47], s66 offen sc1
    buffer_load_dwordx4 v[100:103], v153, s[44:47], s66 offen offset:1024 sc1
    s_waitcnt vmcnt(0)
    v_max3_u32 v8, v96, v97, v98
    v_max3_u32 v8, v99, v100, v8
    v_max3_u32 v8, v101, v102, v8
    v_max_u32 v8, v103, v8
    v_cmp_eq_u32 vcc, -1, v8
    s_cmp_eq_u64 vcc, 0
    s_cbranch_scc1 F_S1K
    s_sub_u32 s67, s67, 1
    s_cbranch_scc0 F_S1
    s_mov_b32 s67, 0
F_S1K:
    v_mfma_f32_32x32x16_bf16 v[124:139], v[96:99], v[120:123], 0
    s_nop 11
    v_max3_f32 v152, v124, v125, v152
    v_max3_f32 v152, v126, v127, v152
    v_max3_f32 v152, v128, v129, v152
    v_max3_f32 v152, v130, v131, v152
    v_max3_f32 v152, v132, v133, v152
    v_max3_f32 v152, v134, v135, v152
    v_max3_f32 v152, v136, v137, v152
    v_max3_f32 v152, v138, v139, v152
    s_add_u32 s66, s66, 2048
    s_cmp_lt_u32 s66, 0x20000
    s_cbranch_scc1 F_S1
    v_mov_b32 v8, v152
    s_nop 1
    v_permlane32_swap_b32 v8, v152
    v_max_f32 v8, v8, v152
    v_mov_b32 v56, 0
    v_mov_b32 v57, 0
    v_mov_b32 v58, 0
    v_mov_b32 v59, 0
    v_mov_b32 v60, 0
    v_mov_b32 v61, 0
    v_mov_b32 v62, 0
    v_mov_b32 v63, 0
    v_mov_b32 v64, 0
    v_mov_b32 v65, 0
    v_mov_b32 v66, 0
    v_mov_b32 v67, 0
    v_mov_b32 v68, 0
    v_mov_b32 v69, 0
    v_mov_b32 v70, 0
    v_mov_b32 v71, 0
    v_mov_b32 v9, v153
    v_mov_b32 v10, v154
    s_mov_b32 s66, 0
F_S2:
    buffer_load_dwordx4 v[96:99], v9, s[44:47], s66 offen sc1
    s_mov_b64 exec, s[68:69]
    buffer_load_dwordx4 v[72:75], v10, s[44:47], s66 offen offset:1024 sc1
    buffer_load_dwordx4 v[76:79], v10, s[44:47], s66 offen offset:1536 sc1
    s_mov_b64 exec, -1
    s_waitcnt vmcnt(0)
    v_mfma_f32_32x32x16_bf16 v[124:139], v[96:99], v[120:123], 0
    s_nop 11
    v_sub_f32 v140, v124, v8
    v_sub_f32 v141, v125, v8
    v_sub_f32 v142, v126, v8
    v_sub_f32 v143, v127, v8
    v_sub_f32 v144, v128, v8
    v_sub_f32 v145, v129, v8
    v_sub_f32 v146, v130, v8
    v_sub_f32 v147, v131, v8
    v_sub_f32 v148, v132, v8
    v_sub_f32 v149, v133, v8
    v_sub_f32 v150, v134, v8
    v_sub_f32 v151, v135, v8
    v_sub_f32 v152, v136, v8
    v_sub_f32 v153, v137, v8
    v_sub_f32 v154, v138, v8
    v_sub_f32 v155, v139, v8
    v_exp_f32 v140, v140
    v_exp_f32 v141, v141
    v_exp_f32 v142, v142
    v_exp_f32 v143, v143
    v_exp_f32 v144, v144
    v_exp_f32 v145, v145
    v_exp_f32 v146, v146
    v_exp_f32 v147, v147
    v_exp_f32 v148, v148
    v_exp_f32 v149, v149
    v_exp_f32 v150, v150
    v_exp_f32 v151, v151
    v_exp_f32 v152, v152
    v_exp_f32 v153, v153
    v_exp_f32 v154, v154
    v_exp_f32 v155, v155
    v_smfmac_f32_32x32x32_bf16 v[56:71], v[72:75], v[140:147], v156
    s_nop 0
    v_smfmac_f32_32x32x32_bf16 v[56:71], v[76:79], v[148:155], v156
    s_add_u32 s66, s66, 2048
    s_cmp_lt_u32 s66, 0x20000
    s_cbranch_scc1 F_S2
    s_nop 8
    v_rcp_f32 v65, v64
    s_nop 7
    v_pk_mul_f32 v[56:57], v[56:57], v[64:65] op_sel:[0,1] op_sel_hi:[1,1]
    v_pk_mul_f32 v[58:59], v[58:59], v[64:65] op_sel:[0,1] op_sel_hi:[1,1]
    v_pk_mul_f32 v[60:61], v[60:61], v[64:65] op_sel:[0,1] op_sel_hi:[1,1]
    v_pk_mul_f32 v[62:63], v[62:63], v[64:65] op_sel:[0,1] op_sel_hi:[1,1]
    v_cvt_pk_bf16_f32 v56, v56, v57
    v_cvt_pk_bf16_f32 v57, v58, v59
    v_cvt_pk_bf16_f32 v58, v60, v61
    v_cvt_pk_bf16_f32 v59, v62, v63
    v_min_u32 v56, -2, v56
    v_min_u32 v57, -2, v57
    v_min_u32 v58, -2, v58
    v_min_u32 v59, -2, v59
    s_branch F_NORM
F_END:
    s_endpgm
.section .rodata,"a"
.p2align 6
.amdhsa_kernel concat_heads__grouped_kv_mqa__ssm_conv_s4d__prompt_kernel
  .amdhsa_next_free_vgpr 168
  .amdhsa_next_free_sgpr 102
  .amdhsa_accum_offset 168
  .amdhsa_group_segment_fixed_size 0
  .amdhsa_kernarg_size 120
  .amdhsa_user_sgpr_count 2
  .amdhsa_user_sgpr_kernarg_segment_ptr 1
  .amdhsa_system_sgpr_workgroup_id_x 1
.end_amdhsa_kernel
```
